```python
import torch

def _softmax(x, axis=-1):
    return torch.softmax(x, dim=axis)
def _gelu(x):
    return torch.nn.functional.gelu(x, approximate="tanh")
def _silu(x):
    return torch.nn.functional.silu(x)
def _sigmoid(x):
    return torch.sigmoid(x)
def _layernorm(x, axis=-1, eps=1e-5):
    m = x.mean(dim=axis, keepdim=True)
    v = x.var(dim=axis, keepdim=True, unbiased=False)
    return (x - m) / torch.sqrt(v + eps)
def _scatter_add(tgt, idx, src, axis=0):
    return tgt.clone().index_add_(axis, idx, src)
def _segment_sum(src, seg, n):
    out = torch.zeros((n,) + src.shape[1:], dtype=src.dtype)
    return out.index_add_(0, seg, src)
def _pad(x, pw):
    flat = tuple(v for pair in reversed(pw) for v in pair)
    return torch.nn.functional.pad(x, flat)

kernel_name = 'gated_mix__grouped_kv_mqa__grouped_kv_mqa__prompt'

def setup_inputs():

    _w = (lambda a: (lambda t: t.to(torch.bfloat16) if t.is_floating_point() else t)(torch.as_tensor(a)))
    def _A_setup():
        B, S, D, H = 1, 2048, 640, 32
        Dh = D // H
        return {
            "x": _w((lambda *s: torch.randn(*s, dtype=torch.bfloat16) * 0.05)(B, S, D)),
            "wq": _w((lambda *s: torch.randn(*s, dtype=torch.bfloat16) * 0.8)(D, H * Dh)),
            "wk": _w((lambda *s: torch.randn(*s, dtype=torch.bfloat16) * 0.8)(D, Dh)),
            "wv": _w((lambda *s: torch.randn(*s, dtype=torch.bfloat16) * 0.05)(D, Dh)),
            "wo": _w((lambda *s: torch.randn(*s, dtype=torch.bfloat16) * 0.05)(H * Dh, D)),
        }
    _A_in = _A_setup()

    def _B_setup():
        B, S, D, H = 1, 2048, 640, 32
        Dh = D // H
        return {
            "x": _w((lambda *s: torch.randn(*s, dtype=torch.bfloat16) * 0.05)(B, S, D)),
            "wq": _w((lambda *s: torch.randn(*s, dtype=torch.bfloat16) * 0.8)(D, H * Dh)),
            "wk": _w((lambda *s: torch.randn(*s, dtype=torch.bfloat16) * 0.8)(D, Dh)),
            "wv": _w((lambda *s: torch.randn(*s, dtype=torch.bfloat16) * 0.05)(D, Dh)),
            "wo": _w((lambda *s: torch.randn(*s, dtype=torch.bfloat16) * 0.05)(H * Dh, D)),
        }
    _B_in = _B_setup()

    return {
        "A_x": _A_in["x"],
        "A_wq": _A_in["wq"],
        "A_wk": _A_in["wk"],
        "A_wv": _A_in["wv"],
        "A_wo": _A_in["wo"],
        "B_x": _B_in["x"],
        "B_wq": _B_in["wq"],
        "B_wk": _B_in["wk"],
        "B_wv": _B_in["wv"],
        "B_wo": _B_in["wo"],
        "gate_w": _w((lambda *s: torch.randn(*s, dtype=torch.bfloat16) * 0.05)(640) * 16.0),
    }

def reference(A_x, A_wq, A_wk, A_wv, A_wo, B_x, B_wq, B_wk, B_wv, B_wo, gate_w):
    def _A_ref(x, wq, wk, wv, wo):
        B, S, D = x.shape
        H = 32
        Dh = D // H
        q = (lambda x, *d: x.permute(*d))((x @ wq).reshape(B, S, H, Dh), 0, 2, 1, 3)
        k = x @ wk
        v = x @ wv
        scores = torch.einsum("bhqd,bkd->bhqk", q, k) * (Dh ** -0.5)
        p = _softmax(scores, axis=-1)
        o = torch.einsum("bhqk,bkd->bhqd", p, v)
        return (lambda x, *d: x.permute(*d))(o, 0, 2, 1, 3).reshape(B, S, H * Dh) @ wo

    def _B_ref(x, wq, wk, wv, wo):
        B, S, D = x.shape
        H = 32
        Dh = D // H
        q = (lambda x, *d: x.permute(*d))((x @ wq).reshape(B, S, H, Dh), 0, 2, 1, 3)
        k = x @ wk
        v = x @ wv
        scores = torch.einsum("bhqd,bkd->bhqk", q, k) * (Dh ** -0.5)
        p = _softmax(scores, axis=-1)
        o = torch.einsum("bhqk,bkd->bhqd", p, v)
        return (lambda x, *d: x.permute(*d))(o, 0, 2, 1, 3).reshape(B, S, H * Dh) @ wo

    x = A_x
    g = _sigmoid((x * gate_w).sum(-1, keepdims=True))
    a = _A_ref(x, A_wq, A_wk, A_wv, A_wo)
    b = _B_ref(x, B_wq, B_wk, B_wv, B_wo)
    return g * a + (1 - g) * b
```

```asm
; @launch grid=(256,1,1) block=(512,1,1) lds=163840
.amdgcn_target "amdgcn-amd-amdhsa--gfx950"
.text
  .globl gated_mix__grouped_kv_mqa__grouped_kv_mqa__prompt_kernel
  .p2align 8
  .type gated_mix__grouped_kv_mqa__grouped_kv_mqa__prompt_kernel,@function
gated_mix__grouped_kv_mqa__grouped_kv_mqa__prompt_kernel:
  s_cmp_ge_u32 s2, 256
  s_cbranch_scc1 L_END
  s_load_dwordx8 s[8:15], s[0:1], 0
  s_load_dwordx8 s[16:23], s[0:1], 48
  s_load_dwordx2 s[24:25], s[0:1], 104
  s_load_dwordx4 s[64:67], s[0:1], 80
  s_load_dwordx2 s[68:69], s[0:1], 32
  s_getpc_b64 s[56:57]
L_PCREF:
  s_lshl_b32 s58, s2, 8
  s_and_b32 s58, s58, 0x7800
  v_lshl_add_u32 v94, v0, 2, s58
  v_min_u32 v94, L_END-L_PCREF, v94
  v_mov_b32 v95, s57
  v_add_co_u32 v94, vcc, s56, v94
  s_nop 1
  v_addc_co_u32 v95, vcc, 0, v95, vcc
  global_load_dword v93, v[94:95], off
  v_lshrrev_b32 v1, 6, v0
  v_and_b32 v0, 63, v0
  s_and_b32 s3, s2, 1
  v_readfirstlane_b32 s6, v1
  s_lshr_b32 s4, s2, 1
  s_and_b32 s4, s4, 3
  s_lshl_b32 s4, s4, 2
  s_lshr_b32 s33, s2, 3
  s_and_b32 s33, s33, 3
  s_add_u32 s4, s4, s33
  s_lshr_b32 s5, s2, 5
  v_lshlrev_b32 v3, 4, v0
  v_lshrrev_b32 v5, 3, v0
  v_and_b32 v6, 7, v0
  v_xor_b32 v6, v6, v5
  v_lshlrev_b32 v6, 4, v6
  v_mul_u32_u24 v2, 1280, v5
  v_add_u32 v2, v2, v6
  v_mov_b32 v4, 0
  s_lshl_b32 s48, s4, 7
  s_lshl_b32 s50, s6, 10
  s_lshr_b32 s70, s5, 1
  s_and_b32 s71, s5, 1
  s_lshl_b32 s54, s70, 2
  s_add_u32 s54, s54, s33
  s_mul_i32 s33, s33, 5
  s_add_u32 s33, s33, 1
  s_lshr_b32 s33, s33, 1
  s_cmp_ge_u32 s6, 4
  s_cbranch_scc1 L_LOADER
  s_lshl_b32 s49, s70, 2
  s_add_u32 s49, s49, s6
  s_lshl_b32 s49, s49, 3
  s_add_u32 s49, s48, s49
  s_mul_i32 s49, s49, 1280
  s_mul_i32 s53, s71, 640
  s_add_u32 s51, s49, s53
  s_sub_u32 s49, s49, s53
  s_mul_i32 s53, s71, 20480
  s_add_u32 s55, s50, s53
  s_sub_u32 s56, s50, s53
  s_and_b32 s52, s6, 1
  s_lshl_b32 s54, s54, 1
  s_add_u32 s54, s54, s52
  s_lshl_b32 s54, s54, 10
  s_waitcnt lgkmcnt(0)
  s_mov_b32 s36, s8
  s_mov_b32 s37, s9
  s_mov_b32 s38, 2621440
  s_mov_b32 s39, 0x00020000
  s_add_u32 m0, s55, 117760
  s_add_u32 s53, s51, 0
  buffer_load_dwordx4 v2, s[36:39], s53 offen lds
  s_mov_b32 s28, s24
  s_mov_b32 s29, s25
  s_mov_b32 s30, 7237888
  s_mov_b32 s31, 0x00020000
  s_cmp_eq_u32 s71, 0
  s_cselect_b32 s12, s12, s14
  s_cselect_b32 s13, s13, s15
  s_cselect_b32 s18, s18, s20
  s_cselect_b32 s19, s19, s21
  s_cmp_eq_u32 s3, 0
  s_cselect_b32 s40, s12, s18
  s_cselect_b32 s41, s13, s19
  s_mov_b32 s42, 25600
  s_mov_b32 s43, 0x00020000
  s_mov_b32 s72, s64
  s_mov_b32 s73, s65
  s_mov_b32 s74, 1280
  s_mov_b32 s75, 0x00020000
  s_cmp_lt_u32 s6, 2
  s_cbranch_scc0 L_LA2
  buffer_load_dwordx4 v[96:99], v3, s[40:43], s54 offen
  s_branch L_LA3
L_LA2:
  s_lshl_b32 s53, s52, 10
  s_add_u32 m0, s53, 25600
  s_nop 0
  buffer_load_dwordx4 v3, s[72:75], s53 offen lds
L_LA3:
  s_add_u32 m0, s55, 121856
  s_add_u32 s53, s51, 128
  buffer_load_dwordx4 v2, s[36:39], s53 offen lds
  s_add_u32 m0, s55, 125952
  s_add_u32 s53, s51, 256
  buffer_load_dwordx4 v2, s[36:39], s53 offen lds
  s_add_u32 m0, s55, 130048
  s_add_u32 s53, s51, 384
  buffer_load_dwordx4 v2, s[36:39], s53 offen lds
  s_add_u32 m0, s55, 134144
  s_add_u32 s53, s51, 512
  buffer_load_dwordx4 v2, s[36:39], s53 offen lds
  s_add_u32 m0, s56, 138240
  s_add_u32 s53, s49, 640
  buffer_load_dwordx4 v2, s[36:39], s53 offen lds
  s_add_u32 m0, s56, 142336
  s_add_u32 s53, s49, 768
  buffer_load_dwordx4 v2, s[36:39], s53 offen lds
  s_add_u32 m0, s56, 146432
  s_add_u32 s53, s49, 896
  buffer_load_dwordx4 v2, s[36:39], s53 offen lds
  s_add_u32 m0, s56, 150528
  s_add_u32 s53, s49, 1024
  buffer_load_dwordx4 v2, s[36:39], s53 offen lds
  s_add_u32 m0, s56, 154624
  s_add_u32 s53, s49, 1152
  buffer_load_dwordx4 v2, s[36:39], s53 offen lds
  s_mov_b32 s53, 7225344
  buffer_load_dword v9, v4, s[28:31], s53 offen sc1
  s_add_u32 m0, s50, 0
  s_add_u32 s53, s50, 0
  buffer_load_dwordx4 v3, s[40:43], s53 offen lds
  s_add_u32 m0, s50, 4096
  s_add_u32 s53, s50, 4096
  buffer_load_dwordx4 v3, s[40:43], s53 offen lds
  s_add_u32 m0, s50, 8192
  s_add_u32 s53, s50, 8192
  buffer_load_dwordx4 v3, s[40:43], s53 offen lds
  s_add_u32 m0, s50, 12288
  s_add_u32 s53, s50, 12288
  buffer_load_dwordx4 v3, s[40:43], s53 offen lds
  s_add_u32 m0, s50, 16384
  s_add_u32 s53, s50, 16384
  buffer_load_dwordx4 v3, s[40:43], s53 offen lds
  s_add_u32 m0, s50, 20480
  s_add_u32 s53, s50, 20480
  buffer_load_dwordx4 v3, s[40:43], s53 offen lds
  s_lshl_b32 s53, s6, 8
  s_add_u32 s53, s53, 24576
  s_mov_b64 exec, 0xffff
  s_add_u32 m0, s53, 0
  s_nop 0
  buffer_load_dwordx4 v3, s[40:43], s53 offen lds
  s_mov_b64 exec, -1
  s_and_b32 s15, s6, 3
  s_lshl_b32 s13, s4, 2
  s_add_u32 s12, s15, s13
  s_lshr_b32 s13, s6, 2
  s_mul_i32 s15, s15, 5120
  s_mul_i32 s14, s13, 2560
  s_add_u32 s15, s15, s14
  s_add_u32 s15, s15, 95232
  v_and_b32 v38, 31, v0
  v_lshrrev_b32 v39, 5, v0
  v_lshlrev_b32 v89, 3, v38
  v_lshl_add_u32 v89, v39, 2, v89
  v_add_u32 v91, s15, v3
  v_add_u32 v92, s15, v89
  v_mul_u32_u24 v90, 20, v39
  v_add_lshl_u32 v90, v90, v38, 4
  s_mul_i32 s26, s12, 81920
  s_lshl_b32 s14, s13, 1
  s_add_u32 s14, s14, s3
  s_lshl_b32 s14, s14, 3
  s_add_u32 s14, s14, s5
  s_mul_i32 s14, s14, 1280
  s_add_u32 s26, s26, s14
  s_add_u32 s26, s26, 344064
  v_lshrrev_b32 v30, 4, v38
  v_mul_u32_u24 v30, 40960, v30
  v_lshl_add_u32 v30, v39, 8, v30
  v_and_b32 v88, 15, v0
  v_lshl_add_u32 v30, v88, 4, v30
  s_mul_i32 s14, s3, 163840
  v_add_u32 v31, s14, v3
  s_lshl_b32 s14, s3, 6
  s_add_u32 s14, s14, s12
  s_lshl_b32 s14, s14, 7
  s_add_u32 s14, s14, 327680
  v_mov_b32 v29, 0x3f803f80
  v_mov_b32 v40, 0
  v_mov_b32 v41, 0
  v_mov_b32 v42, 0
  v_mov_b32 v43, 0
  v_mov_b32 v44, 0
  v_mov_b32 v45, 0
  v_mov_b32 v46, 0
  v_mov_b32 v47, 0
  v_mov_b32 v37, 0x3f803f80
  v_mov_b32 v48, 0
  v_mov_b32 v49, 0
  v_mov_b32 v50, 0
  v_mov_b32 v51, 0
  v_mov_b32 v52, 0
  v_mov_b32 v53, 0
  v_mov_b32 v54, 0
  v_mov_b32 v55, 0
  s_mov_b32 exec_lo, 0x01100000
  s_mov_b32 exec_hi, 0x01100000
  v_mov_b32 v40, 0x3f803f80
  v_mov_b32 v41, 0x3f803f80
  v_mov_b32 v42, 0x3f803f80
  v_mov_b32 v43, 0x3f803f80
  v_mov_b32 v44, 0x3f803f80
  v_mov_b32 v45, 0x3f803f80
  v_mov_b32 v46, 0x3f803f80
  v_mov_b32 v47, 0x3f803f80
  v_mov_b32 v48, 0x3f803f80
  v_mov_b32 v49, 0x3f803f80
  v_mov_b32 v50, 0x3f803f80
  v_mov_b32 v51, 0x3f803f80
  v_mov_b32 v52, 0x3f803f80
  v_mov_b32 v53, 0x3f803f80
  v_mov_b32 v54, 0x3f803f80
  v_mov_b32 v55, 0x3f803f80
  s_mov_b64 exec, -1
  v_mov_b32 v56, 0
  v_mov_b32 v57, 0
  v_mov_b32 v58, 0
  v_mov_b32 v59, 0
  v_mov_b32 v60, 0
  v_mov_b32 v61, 0
  v_mov_b32 v62, 0
  v_mov_b32 v63, 0
  v_mov_b32 v64, 0
  v_mov_b32 v65, 0
  v_mov_b32 v66, 0
  v_mov_b32 v67, 0
  v_mov_b32 v68, 0
  v_mov_b32 v69, 0
  v_mov_b32 v70, 0
  v_mov_b32 v71, 0
  v_mov_b32 v72, 0
  v_mov_b32 v73, 0
  v_mov_b32 v74, 0
  v_mov_b32 v75, 0
  v_mov_b32 v76, 0
  v_mov_b32 v77, 0
  v_mov_b32 v78, 0
  v_mov_b32 v79, 0
  v_mov_b32 v80, 0
  v_mov_b32 v81, 0
  v_mov_b32 v82, 0
  v_mov_b32 v83, 0
  v_mov_b32 v84, 0
  v_mov_b32 v85, 0
  v_mov_b32 v86, 0
  v_mov_b32 v87, 0
  v_mov_b32 v136, 0
  v_mov_b32 v137, 0
  v_mov_b32 v138, 0
  v_mov_b32 v139, 0
  v_mov_b32 v140, 0
  v_mov_b32 v141, 0
  v_mov_b32 v142, 0
  v_mov_b32 v143, 0
  v_mov_b32 v144, 0
  v_mov_b32 v145, 0
  v_mov_b32 v146, 0
  v_mov_b32 v147, 0
  v_mov_b32 v148, 0
  v_mov_b32 v149, 0
  v_mov_b32 v150, 0
  v_mov_b32 v151, 0
  v_and_b32 v5, 15, v0
  v_lshrrev_b32 v6, 4, v0
  v_and_b32 v7, 7, v0
  v_xor_b32 v7, v7, v6
  v_lshlrev_b32 v7, 4, v7
  v_lshl_add_u32 v10, v5, 7, v7
  s_lshl_b32 s53, s52, 11
  s_add_u32 s53, s53, 117760
  v_add_u32 v14, s53, v10
  v_xor_b32 v15, 64, v14
  v_bfe_u32 v7, v0, 2, 2
  v_lshl_add_u32 v7, v6, 3, v7
  v_mul_u32_u24 v18, 40, v7
  v_and_b32 v8, 3, v0
  v_lshlrev_b32 v8, 3, v8
  s_cmp_lt_u32 s6, 2
  s_cselect_b32 s56, -1, 0
  s_cselect_b32 s57, 0, 32
  v_and_b32 v8, s56, v8
  v_add3_u32 v18, v18, v8, s57
  v_lshlrev_b32 v19, 4, v6
  v_add_u32 v19, 25600, v19
  v_lshrrev_b32 v7, 1, v6
  v_lshlrev_b32 v7, 4, v7
  v_and_b32 v8, 1, v6
  v_lshl_add_u32 v7, v8, 2, v7
  v_bfe_u32 v8, v0, 2, 2
  v_add_u32 v7, v7, v8
  v_mul_u32_u24 v7, 160, v7
  v_and_b32 v8, 3, v0
  v_mul_u32_u24 v8, 40, v8
  v_add_u32 v7, v7, v8
  v_add_u32 v250, 39936, v7
  v_add_u32 v251, 84992, v7
  s_cmp_gt_u32 s6, s70
  s_cselect_b32 s62, 1, 0
  s_sub_u32 s62, s6, s62
  s_lshl_b32 s62, s62, 12
  s_lshl_b32 s58, s4, 2
  s_add_u32 s58, s58, s70
  s_lshl_b32 s59, s58, 1
  s_mul_i32 s58, s58, 2560
  s_mul_i32 s60, s3, 163840
  s_add_u32 s58, s58, s60
  s_add_u32 s59, s59, s52
  s_lshl_b32 s60, s3, 7
  s_add_u32 s59, s59, s60
  s_lshl_b32 s59, s59, 6
  s_add_u32 s59, s59, 327680
  v_lshlrev_b32 v13, 2, v5
  s_lshl_b32 s63, s3, 31
  s_xor_b32 s63, s63, 3216550459
  v_lshrrev_b32 v7, 1, v6
  v_and_b32 v8, 1, v6
  s_mov_b32 s27, 1051011932
  s_mov_b64 s[60:61], -1
  s_cmp_eq_u32 s71, 0
  s_cbranch_scc0 L_AD2
  s_cmp_lt_u32 s6, 2
  s_cbranch_scc0 L_AD1
  s_lshl_b32 s53, s52, 8
  s_add_u32 s58, s58, s53
  v_lshlrev_b32 v12, 9, v7
  v_lshl_add_u32 v12, v5, 4, v12
  v_lshl_add_u32 v12, v8, 3, v12
  s_branch L_AD4
L_AD1:
  s_lshl_b32 s53, s52, 7
  s_add_u32 s58, s58, s53
  s_add_u32 s58, s58, 1024
  v_lshlrev_b32 v12, 3, v5
  s_mov_b64 s[60:61], 0xffff
  s_branch L_AD4
L_AD2:
  s_mul_i32 s53, s52, 640
  s_add_u32 s58, s58, s53
  s_add_u32 s58, s58, 1280
  v_mul_u32_u24 v12, 320, v7
  v_lshl_add_u32 v12, v5, 4, v12
  v_lshl_add_u32 v12, v8, 3, v12
  s_mov_b32 s27, 1.0
  s_cmp_lt_u32 s6, 2
  s_cbranch_scc1 L_AD4
  s_add_u32 s58, s58, 256
  s_mov_b32 s60, 0x000f000f
  s_mov_b32 s61, 0x000f000f
L_AD4:
  s_waitcnt vmcnt(0)
  s_barrier
  v_readfirstlane_b32 s34, v9
  s_cmp_eq_u32 s71, 1
  s_cbranch_scc1 L_KV_V
  s_cmp_ge_u32 s6, 2
  s_cbranch_scc1 L_KV_G
  ds_read_b128 v[152:155], v14 offset:0
  ds_read_b64_tr_b16 v[156:157], v18 offset:0
  ds_read_b64_tr_b16 v[158:159], v18 offset:160
  ds_read_b128 v[164:167], v15 offset:0
  ds_read_b64_tr_b16 v[168:169], v18 offset:1280
  ds_read_b64_tr_b16 v[170:171], v18 offset:1440
  ds_read_b128 v[176:179], v14 offset:4096
  ds_read_b64_tr_b16 v[180:181], v18 offset:2560
  ds_read_b64_tr_b16 v[182:183], v18 offset:2720
  ds_read_b128 v[188:191], v15 offset:4096
  ds_read_b64_tr_b16 v[192:193], v18 offset:3840
  ds_read_b64_tr_b16 v[194:195], v18 offset:4000
  ds_read_b128 v[200:203], v14 offset:8192
  ds_read_b64_tr_b16 v[204:205], v18 offset:5120
  ds_read_b64_tr_b16 v[206:207], v18 offset:5280
  s_waitcnt lgkmcnt(12)
  v_mfma_f32_16x16x32_bf16 v[20:23], v[156:159], v[152:155], 0
  ds_read_b128 v[212:215], v15 offset:8192
  ds_read_b64_tr_b16 v[216:217], v18 offset:6400
  ds_read_b64_tr_b16 v[218:219], v18 offset:6560
  s_waitcnt lgkmcnt(12)
  v_mfma_f32_16x16x32_bf16 v[20:23], v[168:171], v[164:167], v[20:23]
  ds_read_b128 v[152:155], v14 offset:12288
  ds_read_b64_tr_b16 v[156:157], v18 offset:7680
  ds_read_b64_tr_b16 v[158:159], v18 offset:7840
  s_waitcnt lgkmcnt(12)
  v_mfma_f32_16x16x32_bf16 v[20:23], v[180:183], v[176:179], v[20:23]
  ds_read_b128 v[164:167], v15 offset:12288
  ds_read_b64_tr_b16 v[168:169], v18 offset:8960
  ds_read_b64_tr_b16 v[170:171], v18 offset:9120
  s_waitcnt lgkmcnt(12)
  v_mfma_f32_16x16x32_bf16 v[20:23], v[192:195], v[188:191], v[20:23]
  ds_read_b128 v[176:179], v14 offset:16384
  ds_read_b64_tr_b16 v[180:181], v18 offset:10240
  ds_read_b64_tr_b16 v[182:183], v18 offset:10400
  s_waitcnt lgkmcnt(12)
  v_mfma_f32_16x16x32_bf16 v[20:23], v[204:207], v[200:203], v[20:23]
  ds_read_b128 v[188:191], v15 offset:16384
  ds_read_b64_tr_b16 v[192:193], v18 offset:11520
  ds_read_b64_tr_b16 v[194:195], v18 offset:11680
  s_waitcnt lgkmcnt(12)
  v_mfma_f32_16x16x32_bf16 v[20:23], v[216:219], v[212:215], v[20:23]
  ds_read_b128 v[200:203], v14 offset:20480
  ds_read_b64_tr_b16 v[204:205], v18 offset:12800
  ds_read_b64_tr_b16 v[206:207], v18 offset:12960
  s_waitcnt lgkmcnt(12)
  v_mfma_f32_16x16x32_bf16 v[20:23], v[156:159], v[152:155], v[20:23]
  ds_read_b128 v[212:215], v15 offset:20480
  ds_read_b64_tr_b16 v[216:217], v18 offset:14080
  ds_read_b64_tr_b16 v[218:219], v18 offset:14240
  s_waitcnt lgkmcnt(12)
  v_mfma_f32_16x16x32_bf16 v[20:23], v[168:171], v[164:167], v[20:23]
  ds_read_b128 v[152:155], v14 offset:24576
  ds_read_b64_tr_b16 v[156:157], v18 offset:15360
  ds_read_b64_tr_b16 v[158:159], v18 offset:15520
  s_waitcnt lgkmcnt(12)
  v_mfma_f32_16x16x32_bf16 v[20:23], v[180:183], v[176:179], v[20:23]
  ds_read_b128 v[164:167], v15 offset:24576
  ds_read_b64_tr_b16 v[168:169], v18 offset:16640
  ds_read_b64_tr_b16 v[170:171], v18 offset:16800
  s_waitcnt lgkmcnt(12)
  v_mfma_f32_16x16x32_bf16 v[20:23], v[192:195], v[188:191], v[20:23]
  ds_read_b128 v[176:179], v14 offset:28672
  ds_read_b64_tr_b16 v[180:181], v18 offset:17920
  ds_read_b64_tr_b16 v[182:183], v18 offset:18080
  s_waitcnt lgkmcnt(12)
  v_mfma_f32_16x16x32_bf16 v[20:23], v[204:207], v[200:203], v[20:23]
  ds_read_b128 v[188:191], v15 offset:28672
  ds_read_b64_tr_b16 v[192:193], v18 offset:19200
  ds_read_b64_tr_b16 v[194:195], v18 offset:19360
  s_waitcnt lgkmcnt(12)
  v_mfma_f32_16x16x32_bf16 v[20:23], v[216:219], v[212:215], v[20:23]
  ds_read_b128 v[200:203], v14 offset:32768
  ds_read_b64_tr_b16 v[204:205], v18 offset:20480
  ds_read_b64_tr_b16 v[206:207], v18 offset:20640
  s_waitcnt lgkmcnt(12)
  v_mfma_f32_16x16x32_bf16 v[20:23], v[156:159], v[152:155], v[20:23]
  ds_read_b128 v[212:215], v15 offset:32768
  ds_read_b64_tr_b16 v[216:217], v18 offset:21760
  ds_read_b64_tr_b16 v[218:219], v18 offset:21920
  s_waitcnt lgkmcnt(12)
  v_mfma_f32_16x16x32_bf16 v[20:23], v[168:171], v[164:167], v[20:23]
  ds_read_b128 v[152:155], v14 offset:36864
  ds_read_b64_tr_b16 v[156:157], v18 offset:23040
  ds_read_b64_tr_b16 v[158:159], v18 offset:23200
  s_waitcnt lgkmcnt(12)
  v_mfma_f32_16x16x32_bf16 v[20:23], v[180:183], v[176:179], v[20:23]
  ds_read_b128 v[164:167], v15 offset:36864
  ds_read_b64_tr_b16 v[168:169], v18 offset:24320
  ds_read_b64_tr_b16 v[170:171], v18 offset:24480
  s_waitcnt lgkmcnt(12)
  v_mfma_f32_16x16x32_bf16 v[20:23], v[192:195], v[188:191], v[20:23]
  s_waitcnt lgkmcnt(9)
  v_mfma_f32_16x16x32_bf16 v[20:23], v[204:207], v[200:203], v[20:23]
  s_waitcnt lgkmcnt(6)
  v_mfma_f32_16x16x32_bf16 v[20:23], v[216:219], v[212:215], v[20:23]
  s_waitcnt lgkmcnt(3)
  v_mfma_f32_16x16x32_bf16 v[20:23], v[156:159], v[152:155], v[20:23]
  s_waitcnt lgkmcnt(0)
  v_mfma_f32_16x16x32_bf16 v[20:23], v[168:171], v[164:167], v[20:23]
  s_branch L_KV_E
L_KV_G:
  ds_read_b128 v[152:155], v14 offset:0
  ds_read_b64_tr_b16 v[156:157], v18 offset:0
  ds_read_b64_tr_b16 v[158:159], v18 offset:160
  ds_read_b128 v[160:163], v19 offset:0
  ds_read_b128 v[164:167], v15 offset:0
  ds_read_b64_tr_b16 v[168:169], v18 offset:1280
  ds_read_b64_tr_b16 v[170:171], v18 offset:1440
  ds_read_b128 v[172:175], v19 offset:64
  ds_read_b128 v[176:179], v14 offset:4096
  ds_read_b64_tr_b16 v[180:181], v18 offset:2560
  ds_read_b64_tr_b16 v[182:183], v18 offset:2720
  ds_read_b128 v[184:187], v19 offset:128
  s_waitcnt lgkmcnt(8)
  v_mfma_f32_16x16x32_bf16 v[20:23], v[156:159], v[152:155], 0
  v_mfma_f32_16x16x32_bf16 v[24:27], v[160:163], v[152:155], 0
  ds_read_b128 v[188:191], v15 offset:4096
  ds_read_b64_tr_b16 v[192:193], v18 offset:3840
  ds_read_b64_tr_b16 v[194:195], v18 offset:4000
  ds_read_b128 v[196:199], v19 offset:192
  s_waitcnt lgkmcnt(8)
  v_mfma_f32_16x16x32_bf16 v[20:23], v[168:171], v[164:167], v[20:23]
  v_mfma_f32_16x16x32_bf16 v[24:27], v[172:175], v[164:167], v[24:27]
  ds_read_b128 v[152:155], v14 offset:8192
  ds_read_b64_tr_b16 v[156:157], v18 offset:5120
  ds_read_b64_tr_b16 v[158:159], v18 offset:5280
  ds_read_b128 v[160:163], v19 offset:256
  s_waitcnt lgkmcnt(8)
  v_mfma_f32_16x16x32_bf16 v[20:23], v[180:183], v[176:179], v[20:23]
  v_mfma_f32_16x16x32_bf16 v[24:27], v[184:187], v[176:179], v[24:27]
  ds_read_b128 v[164:167], v15 offset:8192
  ds_read_b64_tr_b16 v[168:169], v18 offset:6400
  ds_read_b64_tr_b16 v[170:171], v18 offset:6560
  ds_read_b128 v[172:175], v19 offset:320
  s_waitcnt lgkmcnt(8)
  v_mfma_f32_16x16x32_bf16 v[20:23], v[192:195], v[188:191], v[20:23]
  v_mfma_f32_16x16x32_bf16 v[24:27], v[196:199], v[188:191], v[24:27]
  ds_read_b128 v[176:179], v14 offset:12288
  ds_read_b64_tr_b16 v[180:181], v18 offset:7680
  ds_read_b64_tr_b16 v[182:183], v18 offset:7840
  ds_read_b128 v[184:187], v19 offset:384
  s_waitcnt lgkmcnt(8)
  v_mfma_f32_16x16x32_bf16 v[20:23], v[156:159], v[152:155], v[20:23]
  v_mfma_f32_16x16x32_bf16 v[24:27], v[160:163], v[152:155], v[24:27]
  ds_read_b128 v[188:191], v15 offset:12288
  ds_read_b64_tr_b16 v[192:193], v18 offset:8960
  ds_read_b64_tr_b16 v[194:195], v18 offset:9120
  ds_read_b128 v[196:199], v19 offset:448
  s_waitcnt lgkmcnt(8)
  v_mfma_f32_16x16x32_bf16 v[20:23], v[168:171], v[164:167], v[20:23]
  v_mfma_f32_16x16x32_bf16 v[24:27], v[172:175], v[164:167], v[24:27]
  ds_read_b128 v[152:155], v14 offset:16384
  ds_read_b64_tr_b16 v[156:157], v18 offset:10240
  ds_read_b64_tr_b16 v[158:159], v18 offset:10400
  ds_read_b128 v[160:163], v19 offset:512
  s_waitcnt lgkmcnt(8)
  v_mfma_f32_16x16x32_bf16 v[20:23], v[180:183], v[176:179], v[20:23]
  v_mfma_f32_16x16x32_bf16 v[24:27], v[184:187], v[176:179], v[24:27]
  ds_read_b128 v[164:167], v15 offset:16384
  ds_read_b64_tr_b16 v[168:169], v18 offset:11520
  ds_read_b64_tr_b16 v[170:171], v18 offset:11680
  ds_read_b128 v[172:175], v19 offset:576
  s_waitcnt lgkmcnt(8)
  v_mfma_f32_16x16x32_bf16 v[20:23], v[192:195], v[188:191], v[20:23]
  v_mfma_f32_16x16x32_bf16 v[24:27], v[196:199], v[188:191], v[24:27]
  ds_read_b128 v[176:179], v14 offset:20480
  ds_read_b64_tr_b16 v[180:181], v18 offset:12800
  ds_read_b64_tr_b16 v[182:183], v18 offset:12960
  ds_read_b128 v[184:187], v19 offset:640
  s_waitcnt lgkmcnt(8)
  v_mfma_f32_16x16x32_bf16 v[20:23], v[156:159], v[152:155], v[20:23]
  v_mfma_f32_16x16x32_bf16 v[24:27], v[160:163], v[152:155], v[24:27]
  ds_read_b128 v[188:191], v15 offset:20480
  ds_read_b64_tr_b16 v[192:193], v18 offset:14080
  ds_read_b64_tr_b16 v[194:195], v18 offset:14240
  ds_read_b128 v[196:199], v19 offset:704
  s_waitcnt lgkmcnt(8)
  v_mfma_f32_16x16x32_bf16 v[20:23], v[168:171], v[164:167], v[20:23]
  v_mfma_f32_16x16x32_bf16 v[24:27], v[172:175], v[164:167], v[24:27]
  ds_read_b128 v[152:155], v14 offset:24576
  ds_read_b64_tr_b16 v[156:157], v18 offset:15360
  ds_read_b64_tr_b16 v[158:159], v18 offset:15520
  ds_read_b128 v[160:163], v19 offset:768
  s_waitcnt lgkmcnt(8)
  v_mfma_f32_16x16x32_bf16 v[20:23], v[180:183], v[176:179], v[20:23]
  v_mfma_f32_16x16x32_bf16 v[24:27], v[184:187], v[176:179], v[24:27]
  ds_read_b128 v[164:167], v15 offset:24576
  ds_read_b64_tr_b16 v[168:169], v18 offset:16640
  ds_read_b64_tr_b16 v[170:171], v18 offset:16800
  ds_read_b128 v[172:175], v19 offset:832
  s_waitcnt lgkmcnt(8)
  v_mfma_f32_16x16x32_bf16 v[20:23], v[192:195], v[188:191], v[20:23]
  v_mfma_f32_16x16x32_bf16 v[24:27], v[196:199], v[188:191], v[24:27]
  ds_read_b128 v[176:179], v14 offset:28672
  ds_read_b64_tr_b16 v[180:181], v18 offset:17920
  ds_read_b64_tr_b16 v[182:183], v18 offset:18080
  ds_read_b128 v[184:187], v19 offset:896
  s_waitcnt lgkmcnt(8)
  v_mfma_f32_16x16x32_bf16 v[20:23], v[156:159], v[152:155], v[20:23]
  v_mfma_f32_16x16x32_bf16 v[24:27], v[160:163], v[152:155], v[24:27]
  ds_read_b128 v[188:191], v15 offset:28672
  ds_read_b64_tr_b16 v[192:193], v18 offset:19200
  ds_read_b64_tr_b16 v[194:195], v18 offset:19360
  ds_read_b128 v[196:199], v19 offset:960
  s_waitcnt lgkmcnt(8)
  v_mfma_f32_16x16x32_bf16 v[20:23], v[168:171], v[164:167], v[20:23]
  v_mfma_f32_16x16x32_bf16 v[24:27], v[172:175], v[164:167], v[24:27]
  ds_read_b128 v[152:155], v14 offset:32768
  ds_read_b64_tr_b16 v[156:157], v18 offset:20480
  ds_read_b64_tr_b16 v[158:159], v18 offset:20640
  ds_read_b128 v[160:163], v19 offset:1024
  s_waitcnt lgkmcnt(8)
  v_mfma_f32_16x16x32_bf16 v[20:23], v[180:183], v[176:179], v[20:23]
  v_mfma_f32_16x16x32_bf16 v[24:27], v[184:187], v[176:179], v[24:27]
  ds_read_b128 v[164:167], v15 offset:32768
  ds_read_b64_tr_b16 v[168:169], v18 offset:21760
  ds_read_b64_tr_b16 v[170:171], v18 offset:21920
  ds_read_b128 v[172:175], v19 offset:1088
  s_waitcnt lgkmcnt(8)
  v_mfma_f32_16x16x32_bf16 v[20:23], v[192:195], v[188:191], v[20:23]
  v_mfma_f32_16x16x32_bf16 v[24:27], v[196:199], v[188:191], v[24:27]
  ds_read_b128 v[176:179], v14 offset:36864
  ds_read_b64_tr_b16 v[180:181], v18 offset:23040
  ds_read_b64_tr_b16 v[182:183], v18 offset:23200
  ds_read_b128 v[184:187], v19 offset:1152
  s_waitcnt lgkmcnt(8)
  v_mfma_f32_16x16x32_bf16 v[20:23], v[156:159], v[152:155], v[20:23]
  v_mfma_f32_16x16x32_bf16 v[24:27], v[160:163], v[152:155], v[24:27]
  ds_read_b128 v[188:191], v15 offset:36864
  ds_read_b64_tr_b16 v[192:193], v18 offset:24320
  ds_read_b64_tr_b16 v[194:195], v18 offset:24480
  ds_read_b128 v[196:199], v19 offset:1216
  s_waitcnt lgkmcnt(8)
  v_mfma_f32_16x16x32_bf16 v[20:23], v[168:171], v[164:167], v[20:23]
  v_mfma_f32_16x16x32_bf16 v[24:27], v[172:175], v[164:167], v[24:27]
  s_waitcnt lgkmcnt(4)
  v_mfma_f32_16x16x32_bf16 v[20:23], v[180:183], v[176:179], v[20:23]
  v_mfma_f32_16x16x32_bf16 v[24:27], v[184:187], v[176:179], v[24:27]
  s_waitcnt lgkmcnt(0)
  v_mfma_f32_16x16x32_bf16 v[20:23], v[192:195], v[188:191], v[20:23]
  v_mfma_f32_16x16x32_bf16 v[24:27], v[196:199], v[188:191], v[24:27]
  s_nop 7
  v_mul_f32 v24, s63, v24
  v_exp_f32 v24, v24
  s_nop 0
  v_add_f32 v24, 1.0, v24
  v_rcp_f32 v24, v24
  s_mov_b64 exec, 0xffff
  buffer_store_dword v24, v13, s[28:31], s59 offen sc1
  s_mov_b64 exec, -1
  s_branch L_KV_E
L_KV_V:
  ds_read_b128 v[152:155], v14 offset:0
  ds_read_b64_tr_b16 v[156:157], v18 offset:0
  ds_read_b64_tr_b16 v[158:159], v18 offset:160
  ds_read_b128 v[164:167], v15 offset:0
  ds_read_b64_tr_b16 v[168:169], v18 offset:1280
  ds_read_b64_tr_b16 v[170:171], v18 offset:1440
  ds_read_b128 v[176:179], v14 offset:4096
  ds_read_b64_tr_b16 v[180:181], v18 offset:2560
  ds_read_b64_tr_b16 v[182:183], v18 offset:2720
  ds_read_b128 v[188:191], v15 offset:4096
  ds_read_b64_tr_b16 v[192:193], v18 offset:3840
  ds_read_b64_tr_b16 v[194:195], v18 offset:4000
  ds_read_b128 v[200:203], v14 offset:8192
  ds_read_b64_tr_b16 v[204:205], v18 offset:5120
  ds_read_b64_tr_b16 v[206:207], v18 offset:5280
  s_waitcnt lgkmcnt(12)
  v_mfma_f32_16x16x32_bf16 v[20:23], v[152:155], v[156:159], 0
  ds_read_b128 v[212:215], v15 offset:8192
  ds_read_b64_tr_b16 v[216:217], v18 offset:6400
  ds_read_b64_tr_b16 v[218:219], v18 offset:6560
  s_waitcnt lgkmcnt(12)
  v_mfma_f32_16x16x32_bf16 v[20:23], v[164:167], v[168:171], v[20:23]
  ds_read_b128 v[152:155], v14 offset:12288
  ds_read_b64_tr_b16 v[156:157], v18 offset:7680
  ds_read_b64_tr_b16 v[158:159], v18 offset:7840
  s_waitcnt lgkmcnt(12)
  v_mfma_f32_16x16x32_bf16 v[20:23], v[176:179], v[180:183], v[20:23]
  ds_read_b128 v[164:167], v15 offset:12288
  ds_read_b64_tr_b16 v[168:169], v18 offset:8960
  ds_read_b64_tr_b16 v[170:171], v18 offset:9120
  s_waitcnt lgkmcnt(12)
  v_mfma_f32_16x16x32_bf16 v[20:23], v[188:191], v[192:195], v[20:23]
  ds_read_b128 v[176:179], v14 offset:16384
  ds_read_b64_tr_b16 v[180:181], v18 offset:10240
  ds_read_b64_tr_b16 v[182:183], v18 offset:10400
  s_waitcnt lgkmcnt(12)
  v_mfma_f32_16x16x32_bf16 v[20:23], v[200:203], v[204:207], v[20:23]
  ds_read_b128 v[188:191], v15 offset:16384
  ds_read_b64_tr_b16 v[192:193], v18 offset:11520
  ds_read_b64_tr_b16 v[194:195], v18 offset:11680
  s_waitcnt lgkmcnt(12)
  v_mfma_f32_16x16x32_bf16 v[20:23], v[212:215], v[216:219], v[20:23]
  ds_read_b128 v[200:203], v14 offset:20480
  ds_read_b64_tr_b16 v[204:205], v18 offset:12800
  ds_read_b64_tr_b16 v[206:207], v18 offset:12960
  s_waitcnt lgkmcnt(12)
  v_mfma_f32_16x16x32_bf16 v[20:23], v[152:155], v[156:159], v[20:23]
  ds_read_b128 v[212:215], v15 offset:20480
  ds_read_b64_tr_b16 v[216:217], v18 offset:14080
  ds_read_b64_tr_b16 v[218:219], v18 offset:14240
  s_waitcnt lgkmcnt(12)
  v_mfma_f32_16x16x32_bf16 v[20:23], v[164:167], v[168:171], v[20:23]
  ds_read_b128 v[152:155], v14 offset:24576
  ds_read_b64_tr_b16 v[156:157], v18 offset:15360
  ds_read_b64_tr_b16 v[158:159], v18 offset:15520
  s_waitcnt lgkmcnt(12)
  v_mfma_f32_16x16x32_bf16 v[20:23], v[176:179], v[180:183], v[20:23]
  ds_read_b128 v[164:167], v15 offset:24576
  ds_read_b64_tr_b16 v[168:169], v18 offset:16640
  ds_read_b64_tr_b16 v[170:171], v18 offset:16800
  s_waitcnt lgkmcnt(12)
  v_mfma_f32_16x16x32_bf16 v[20:23], v[188:191], v[192:195], v[20:23]
  ds_read_b128 v[176:179], v14 offset:28672
  ds_read_b64_tr_b16 v[180:181], v18 offset:17920
  ds_read_b64_tr_b16 v[182:183], v18 offset:18080
  s_waitcnt lgkmcnt(12)
  v_mfma_f32_16x16x32_bf16 v[20:23], v[200:203], v[204:207], v[20:23]
  ds_read_b128 v[188:191], v15 offset:28672
  ds_read_b64_tr_b16 v[192:193], v18 offset:19200
  ds_read_b64_tr_b16 v[194:195], v18 offset:19360
  s_waitcnt lgkmcnt(12)
  v_mfma_f32_16x16x32_bf16 v[20:23], v[212:215], v[216:219], v[20:23]
  ds_read_b128 v[200:203], v14 offset:32768
  ds_read_b64_tr_b16 v[204:205], v18 offset:20480
  ds_read_b64_tr_b16 v[206:207], v18 offset:20640
  s_waitcnt lgkmcnt(12)
  v_mfma_f32_16x16x32_bf16 v[20:23], v[152:155], v[156:159], v[20:23]
  ds_read_b128 v[212:215], v15 offset:32768
  ds_read_b64_tr_b16 v[216:217], v18 offset:21760
  ds_read_b64_tr_b16 v[218:219], v18 offset:21920
  s_waitcnt lgkmcnt(12)
  v_mfma_f32_16x16x32_bf16 v[20:23], v[164:167], v[168:171], v[20:23]
  ds_read_b128 v[152:155], v14 offset:36864
  ds_read_b64_tr_b16 v[156:157], v18 offset:23040
  ds_read_b64_tr_b16 v[158:159], v18 offset:23200
  s_waitcnt lgkmcnt(12)
  v_mfma_f32_16x16x32_bf16 v[20:23], v[176:179], v[180:183], v[20:23]
  ds_read_b128 v[164:167], v15 offset:36864
  ds_read_b64_tr_b16 v[168:169], v18 offset:24320
  ds_read_b64_tr_b16 v[170:171], v18 offset:24480
  s_waitcnt lgkmcnt(12)
  v_mfma_f32_16x16x32_bf16 v[20:23], v[188:191], v[192:195], v[20:23]
  s_waitcnt lgkmcnt(9)
  v_mfma_f32_16x16x32_bf16 v[20:23], v[200:203], v[204:207], v[20:23]
  s_waitcnt lgkmcnt(6)
  v_mfma_f32_16x16x32_bf16 v[20:23], v[212:215], v[216:219], v[20:23]
  s_waitcnt lgkmcnt(3)
  v_mfma_f32_16x16x32_bf16 v[20:23], v[152:155], v[156:159], v[20:23]
  s_waitcnt lgkmcnt(0)
  v_mfma_f32_16x16x32_bf16 v[20:23], v[164:167], v[168:171], v[20:23]
L_KV_E:
  s_add_u32 s55, s33, 0
  s_cmp_ge_u32 s55, 10
  s_cselect_b32 s56, 10, 0
  s_sub_u32 s55, s55, s56
  s_lshl_b32 s55, s55, 12
  s_add_u32 s55, s55, 117760
  s_add_u32 s56, s62, 27648
  s_cmp_eq_u32 s6, s70
  s_cselect_b32 s55, s55, s56
  v_add_u32 v248, s55, v10
  v_xor_b32 v249, 64, v248
  v_mul_f32 v20, s27, v20
  v_mul_f32 v21, s27, v21
  v_mul_f32 v22, s27, v22
  v_mul_f32 v23, s27, v23
  v_cvt_pk_bf16_f32 v16, v20, v21
  v_cvt_pk_bf16_f32 v17, v22, v23
  s_mov_b64 exec, s[60:61]
  buffer_store_dwordx2 v[16:17], v12, s[28:31], s58 offen sc1
  s_mov_b64 exec, -1
  s_mul_i32 s34, s34, 0x9e3779b1
  s_add_u32 s34, s34, 0x7f4a7c15
  s_mul_i32 s7, s6, 5120
  s_add_u32 s7, s7, 95232
  v_mul_u32_u24 v12, 1280, v6
  v_add_u32 v12, s7, v12
  v_lshl_add_u32 v13, v5, 3, v12
  v_lshl_add_u32 v12, v5, 4, v12
  s_barrier
  ds_read_b128 v[152:155], v248 offset:0
  ds_read_b128 v[156:159], v248 offset:2048
  ds_read_b64_tr_b16 v[160:161], v250 offset:0
  ds_read_b64_tr_b16 v[162:163], v250 offset:1280
  ds_read_b64_tr_b16 v[164:165], v250 offset:8
  ds_read_b64_tr_b16 v[166:167], v250 offset:1288
  ds_read_b64_tr_b16 v[168:169], v250 offset:16
  ds_read_b64_tr_b16 v[170:171], v250 offset:1296
  ds_read_b64_tr_b16 v[172:173], v250 offset:24
  ds_read_b64_tr_b16 v[174:175], v250 offset:1304
  ds_read_b64_tr_b16 v[176:177], v250 offset:32
  ds_read_b64_tr_b16 v[178:179], v250 offset:1312
  s_waitcnt lgkmcnt(3)
  ds_read_b128 v[180:183], v249 offset:0
  ds_read_b128 v[184:187], v249 offset:2048
  ds_read_b64_tr_b16 v[188:189], v250 offset:5120
  ds_read_b64_tr_b16 v[190:191], v250 offset:6400
  ds_read_b64_tr_b16 v[192:193], v250 offset:5128
  ds_read_b64_tr_b16 v[194:195], v250 offset:6408
  ds_read_b64_tr_b16 v[196:197], v250 offset:5136
  ds_read_b64_tr_b16 v[198:199], v250 offset:6416
  ds_read_b64_tr_b16 v[200:201], v250 offset:5144
  ds_read_b64_tr_b16 v[202:203], v250 offset:6424
  ds_read_b64_tr_b16 v[204:205], v250 offset:5152
  ds_read_b64_tr_b16 v[206:207], v250 offset:6432
  s_add_u32 s55, s33, 1
  s_cmp_ge_u32 s55, 10
  s_cselect_b32 s56, 10, 0
  s_sub_u32 s55, s55, s56
  s_lshl_b32 s55, s55, 12
  s_add_u32 s55, s55, 117760
  s_add_u32 s56, s62, 50176
  s_cmp_eq_u32 s6, s70
  s_cselect_b32 s55, s55, s56
  v_add_u32 v248, s55, v10
  v_xor_b32 v249, 64, v248
  s_waitcnt lgkmcnt(0)
  s_waitcnt vmcnt(0)
  s_barrier
  s_cmp_eq_u32 s6, 0
  s_cbranch_scc0 L_NOPUB
  s_bfe_u32 s56, s2, 0x50001
  s_lshl_b32 s56, s56, 7
  s_lshl_b32 s57, s3, 12
  s_add_u32 s56, s56, s57
  s_lshr_b32 s57, s2, 6
  s_lshl_b32 s57, s57, 2
  s_add_u32 s56, s56, s57
  s_add_u32 s56, s56, 7225600
  v_mov_b32 v7, s34
  s_mov_b64 exec, 1
  buffer_store_dword v7, v4, s[28:31], s56 offen sc1
  s_mov_b64 exec, -1
L_NOPUB:
  v_mfma_f32_16x16x32_bf16 v[208:211], v[160:163], v[152:155], 0
  ds_read_b128 v[100:103], v248 offset:0
  ds_read_b128 v[104:107], v248 offset:2048
  v_mfma_f32_16x16x32_bf16 v[228:231], v[160:163], v[156:159], 0
  ds_read_b64_tr_b16 v[108:109], v250 offset:22528
  ds_read_b64_tr_b16 v[110:111], v250 offset:23808
  v_mfma_f32_16x16x32_bf16 v[212:215], v[164:167], v[152:155], 0
  ds_read_b64_tr_b16 v[112:113], v250 offset:22536
  ds_read_b64_tr_b16 v[114:115], v250 offset:23816
  v_mfma_f32_16x16x32_bf16 v[232:235], v[164:167], v[156:159], 0
  ds_read_b64_tr_b16 v[116:117], v250 offset:22544
  ds_read_b64_tr_b16 v[118:119], v250 offset:23824
  v_mfma_f32_16x16x32_bf16 v[216:219], v[168:171], v[152:155], 0
  ds_read_b64_tr_b16 v[120:121], v250 offset:22552
  ds_read_b64_tr_b16 v[122:123], v250 offset:23832
  v_mfma_f32_16x16x32_bf16 v[236:239], v[168:171], v[156:159], 0
  ds_read_b64_tr_b16 v[124:125], v250 offset:22560
  ds_read_b64_tr_b16 v[126:127], v250 offset:23840
  v_mfma_f32_16x16x32_bf16 v[220:223], v[172:175], v[152:155], 0
  v_mfma_f32_16x16x32_bf16 v[240:243], v[172:175], v[156:159], 0
  v_mfma_f32_16x16x32_bf16 v[224:227], v[176:179], v[152:155], 0
  v_mfma_f32_16x16x32_bf16 v[244:247], v[176:179], v[156:159], 0
  s_waitcnt lgkmcnt(3)
  v_mfma_f32_16x16x32_bf16 v[208:211], v[188:191], v[180:183], v[208:211]
  ds_read_b128 v[152:155], v249 offset:0
  ds_read_b128 v[156:159], v249 offset:2048
  v_mfma_f32_16x16x32_bf16 v[228:231], v[188:191], v[184:187], v[228:231]
  ds_read_b64_tr_b16 v[160:161], v250 offset:27648
  ds_read_b64_tr_b16 v[162:163], v250 offset:28928
  v_mfma_f32_16x16x32_bf16 v[212:215], v[192:195], v[180:183], v[212:215]
  ds_read_b64_tr_b16 v[164:165], v250 offset:27656
  ds_read_b64_tr_b16 v[166:167], v250 offset:28936
  v_mfma_f32_16x16x32_bf16 v[232:235], v[192:195], v[184:187], v[232:235]
  ds_read_b64_tr_b16 v[168:169], v250 offset:27664
  ds_read_b64_tr_b16 v[170:171], v250 offset:28944
  v_mfma_f32_16x16x32_bf16 v[216:219], v[196:199], v[180:183], v[216:219]
  ds_read_b64_tr_b16 v[172:173], v250 offset:27672
  ds_read_b64_tr_b16 v[174:175], v250 offset:28952
  v_mfma_f32_16x16x32_bf16 v[236:239], v[196:199], v[184:187], v[236:239]
  ds_read_b64_tr_b16 v[176:177], v250 offset:27680
  ds_read_b64_tr_b16 v[178:179], v250 offset:28960
  v_mfma_f32_16x16x32_bf16 v[220:223], v[200:203], v[180:183], v[220:223]
  s_add_u32 s55, s33, 2
  s_cmp_ge_u32 s55, 10
  s_cselect_b32 s56, 10, 0
  v_mfma_f32_16x16x32_bf16 v[240:243], v[200:203], v[184:187], v[240:243]
  s_sub_u32 s55, s55, s56
  s_lshl_b32 s55, s55, 12
  s_add_u32 s55, s55, 117760
  v_mfma_f32_16x16x32_bf16 v[224:227], v[204:207], v[180:183], v[224:227]
  s_add_u32 s56, s62, 72704
  s_cmp_eq_u32 s6, s70
  s_cselect_b32 s55, s55, s56
  v_mfma_f32_16x16x32_bf16 v[244:247], v[204:207], v[184:187], v[244:247]
  v_add_u32 v248, s55, v10
  v_xor_b32 v249, 64, v248
  s_waitcnt lgkmcnt(0)
  s_barrier
  v_mfma_f32_16x16x32_bf16 v[208:211], v[108:111], v[100:103], v[208:211]
  ds_read_b128 v[180:183], v248 offset:0
  ds_read_b128 v[184:187], v248 offset:2048
  v_mfma_f32_16x16x32_bf16 v[228:231], v[108:111], v[104:107], v[228:231]
  ds_read_b64_tr_b16 v[188:189], v251 offset:0
  ds_read_b64_tr_b16 v[190:191], v251 offset:1280
  v_mfma_f32_16x16x32_bf16 v[212:215], v[112:115], v[100:103], v[212:215]
  ds_read_b64_tr_b16 v[192:193], v251 offset:8
  ds_read_b64_tr_b16 v[194:195], v251 offset:1288
  v_mfma_f32_16x16x32_bf16 v[232:235], v[112:115], v[104:107], v[232:235]
  ds_read_b64_tr_b16 v[196:197], v251 offset:16
  ds_read_b64_tr_b16 v[198:199], v251 offset:1296
  v_mfma_f32_16x16x32_bf16 v[216:219], v[116:119], v[100:103], v[216:219]
  ds_read_b64_tr_b16 v[200:201], v251 offset:24
  ds_read_b64_tr_b16 v[202:203], v251 offset:1304
  v_mfma_f32_16x16x32_bf16 v[236:239], v[116:119], v[104:107], v[236:239]
  ds_read_b64_tr_b16 v[204:205], v251 offset:32
  ds_read_b64_tr_b16 v[206:207], v251 offset:1312
  v_mfma_f32_16x16x32_bf16 v[220:223], v[120:123], v[100:103], v[220:223]
  v_mfma_f32_16x16x32_bf16 v[240:243], v[120:123], v[104:107], v[240:243]
  v_mfma_f32_16x16x32_bf16 v[224:227], v[124:127], v[100:103], v[224:227]
  v_mfma_f32_16x16x32_bf16 v[244:247], v[124:127], v[104:107], v[244:247]
  s_waitcnt lgkmcnt(3)
  v_mfma_f32_16x16x32_bf16 v[208:211], v[160:163], v[152:155], v[208:211]
  ds_read_b128 v[100:103], v249 offset:0
  ds_read_b128 v[104:107], v249 offset:2048
  v_mfma_f32_16x16x32_bf16 v[228:231], v[160:163], v[156:159], v[228:231]
  ds_read_b64_tr_b16 v[108:109], v251 offset:5120
  ds_read_b64_tr_b16 v[110:111], v251 offset:6400
  v_mfma_f32_16x16x32_bf16 v[212:215], v[164:167], v[152:155], v[212:215]
  ds_read_b64_tr_b16 v[112:113], v251 offset:5128
  ds_read_b64_tr_b16 v[114:115], v251 offset:6408
  v_mfma_f32_16x16x32_bf16 v[232:235], v[164:167], v[156:159], v[232:235]
  ds_read_b64_tr_b16 v[116:117], v251 offset:5136
  ds_read_b64_tr_b16 v[118:119], v251 offset:6416
  v_mfma_f32_16x16x32_bf16 v[216:219], v[168:171], v[152:155], v[216:219]
  ds_read_b64_tr_b16 v[120:121], v251 offset:5144
  ds_read_b64_tr_b16 v[122:123], v251 offset:6424
  v_mfma_f32_16x16x32_bf16 v[236:239], v[168:171], v[156:159], v[236:239]
  ds_read_b64_tr_b16 v[124:125], v251 offset:5152
  ds_read_b64_tr_b16 v[126:127], v251 offset:6432
  v_mfma_f32_16x16x32_bf16 v[220:223], v[172:175], v[152:155], v[220:223]
  s_add_u32 s55, s33, 3
  s_cmp_ge_u32 s55, 10
  s_cselect_b32 s56, 10, 0
  v_mfma_f32_16x16x32_bf16 v[240:243], v[172:175], v[156:159], v[240:243]
  s_sub_u32 s55, s55, s56
  s_lshl_b32 s55, s55, 12
  s_add_u32 s55, s55, 117760
  v_mfma_f32_16x16x32_bf16 v[224:227], v[176:179], v[152:155], v[224:227]
  s_add_u32 s56, s62, 95232
  s_cmp_eq_u32 s6, s70
  s_cselect_b32 s55, s55, s56
  v_mfma_f32_16x16x32_bf16 v[244:247], v[176:179], v[156:159], v[244:247]
  v_add_u32 v248, s55, v10
  v_xor_b32 v249, 64, v248
  s_waitcnt lgkmcnt(0)
  s_barrier
  v_mfma_f32_16x16x32_bf16 v[208:211], v[188:191], v[180:183], v[208:211]
  ds_read_b128 v[152:155], v248 offset:0
  ds_read_b128 v[156:159], v248 offset:2048
  v_mfma_f32_16x16x32_bf16 v[228:231], v[188:191], v[184:187], v[228:231]
  ds_read_b64_tr_b16 v[160:161], v251 offset:22528
  ds_read_b64_tr_b16 v[162:163], v251 offset:23808
  v_mfma_f32_16x16x32_bf16 v[212:215], v[192:195], v[180:183], v[212:215]
  ds_read_b64_tr_b16 v[164:165], v251 offset:22536
  ds_read_b64_tr_b16 v[166:167], v251 offset:23816
  v_mfma_f32_16x16x32_bf16 v[232:235], v[192:195], v[184:187], v[232:235]
  ds_read_b64_tr_b16 v[168:169], v251 offset:22544
  ds_read_b64_tr_b16 v[170:171], v251 offset:23824
  v_mfma_f32_16x16x32_bf16 v[216:219], v[196:199], v[180:183], v[216:219]
  ds_read_b64_tr_b16 v[172:173], v251 offset:22552
  ds_read_b64_tr_b16 v[174:175], v251 offset:23832
  v_mfma_f32_16x16x32_bf16 v[236:239], v[196:199], v[184:187], v[236:239]
  ds_read_b64_tr_b16 v[176:177], v251 offset:22560
  ds_read_b64_tr_b16 v[178:179], v251 offset:23840
  v_mfma_f32_16x16x32_bf16 v[220:223], v[200:203], v[180:183], v[220:223]
  v_mfma_f32_16x16x32_bf16 v[240:243], v[200:203], v[184:187], v[240:243]
  v_mfma_f32_16x16x32_bf16 v[224:227], v[204:207], v[180:183], v[224:227]
  v_mfma_f32_16x16x32_bf16 v[244:247], v[204:207], v[184:187], v[244:247]
  s_waitcnt lgkmcnt(3)
  v_mfma_f32_16x16x32_bf16 v[208:211], v[108:111], v[100:103], v[208:211]
  ds_read_b128 v[180:183], v249 offset:0
  ds_read_b128 v[184:187], v249 offset:2048
  v_mfma_f32_16x16x32_bf16 v[228:231], v[108:111], v[104:107], v[228:231]
  ds_read_b64_tr_b16 v[188:189], v251 offset:27648
  ds_read_b64_tr_b16 v[190:191], v251 offset:28928
  v_mfma_f32_16x16x32_bf16 v[212:215], v[112:115], v[100:103], v[212:215]
  ds_read_b64_tr_b16 v[192:193], v251 offset:27656
  ds_read_b64_tr_b16 v[194:195], v251 offset:28936
  v_mfma_f32_16x16x32_bf16 v[232:235], v[112:115], v[104:107], v[232:235]
  ds_read_b64_tr_b16 v[196:197], v251 offset:27664
  ds_read_b64_tr_b16 v[198:199], v251 offset:28944
  v_mfma_f32_16x16x32_bf16 v[216:219], v[116:119], v[100:103], v[216:219]
  ds_read_b64_tr_b16 v[200:201], v251 offset:27672
  ds_read_b64_tr_b16 v[202:203], v251 offset:28952
  v_mfma_f32_16x16x32_bf16 v[236:239], v[116:119], v[104:107], v[236:239]
  ds_read_b64_tr_b16 v[204:205], v251 offset:27680
  ds_read_b64_tr_b16 v[206:207], v251 offset:28960
  v_mfma_f32_16x16x32_bf16 v[220:223], v[120:123], v[100:103], v[220:223]
  s_add_u32 s55, s33, 4
  s_cmp_ge_u32 s55, 10
  s_cselect_b32 s56, 10, 0
  v_mfma_f32_16x16x32_bf16 v[240:243], v[120:123], v[104:107], v[240:243]
  s_sub_u32 s55, s55, s56
  s_lshl_b32 s55, s55, 12
  s_add_u32 s55, s55, 117760
  v_mfma_f32_16x16x32_bf16 v[224:227], v[124:127], v[100:103], v[224:227]
  s_add_u32 s56, s62, 27648
  s_cmp_eq_u32 s6, s70
  s_cselect_b32 s55, s55, s56
  v_mfma_f32_16x16x32_bf16 v[244:247], v[124:127], v[104:107], v[244:247]
  v_add_u32 v248, s55, v10
  v_xor_b32 v249, 64, v248
  s_waitcnt lgkmcnt(0)
  s_barrier
  v_mfma_f32_16x16x32_bf16 v[208:211], v[160:163], v[152:155], v[208:211]
  ds_read_b128 v[100:103], v248 offset:0
  ds_read_b128 v[104:107], v248 offset:2048
  v_mfma_f32_16x16x32_bf16 v[228:231], v[160:163], v[156:159], v[228:231]
  ds_read_b64_tr_b16 v[108:109], v250 offset:0
  ds_read_b64_tr_b16 v[110:111], v250 offset:1280
  v_mfma_f32_16x16x32_bf16 v[212:215], v[164:167], v[152:155], v[212:215]
  ds_read_b64_tr_b16 v[112:113], v250 offset:8
  ds_read_b64_tr_b16 v[114:115], v250 offset:1288
  v_mfma_f32_16x16x32_bf16 v[232:235], v[164:167], v[156:159], v[232:235]
  ds_read_b64_tr_b16 v[116:117], v250 offset:16
  ds_read_b64_tr_b16 v[118:119], v250 offset:1296
  v_mfma_f32_16x16x32_bf16 v[216:219], v[168:171], v[152:155], v[216:219]
  ds_read_b64_tr_b16 v[120:121], v250 offset:24
  ds_read_b64_tr_b16 v[122:123], v250 offset:1304
  v_mfma_f32_16x16x32_bf16 v[236:239], v[168:171], v[156:159], v[236:239]
  ds_read_b64_tr_b16 v[124:125], v250 offset:32
  ds_read_b64_tr_b16 v[126:127], v250 offset:1312
  v_mfma_f32_16x16x32_bf16 v[220:223], v[172:175], v[152:155], v[220:223]
  v_mfma_f32_16x16x32_bf16 v[240:243], v[172:175], v[156:159], v[240:243]
  v_mfma_f32_16x16x32_bf16 v[224:227], v[176:179], v[152:155], v[224:227]
  v_mfma_f32_16x16x32_bf16 v[244:247], v[176:179], v[156:159], v[244:247]
  s_waitcnt lgkmcnt(3)
  v_mfma_f32_16x16x32_bf16 v[208:211], v[188:191], v[180:183], v[208:211]
  ds_read_b128 v[152:155], v249 offset:0
  ds_read_b128 v[156:159], v249 offset:2048
  v_mfma_f32_16x16x32_bf16 v[228:231], v[188:191], v[184:187], v[228:231]
  ds_read_b64_tr_b16 v[160:161], v250 offset:5120
  ds_read_b64_tr_b16 v[162:163], v250 offset:6400
  v_mfma_f32_16x16x32_bf16 v[212:215], v[192:195], v[180:183], v[212:215]
  ds_read_b64_tr_b16 v[164:165], v250 offset:5128
  ds_read_b64_tr_b16 v[166:167], v250 offset:6408
  v_mfma_f32_16x16x32_bf16 v[232:235], v[192:195], v[184:187], v[232:235]
  ds_read_b64_tr_b16 v[168:169], v250 offset:5136
  ds_read_b64_tr_b16 v[170:171], v250 offset:6416
  v_mfma_f32_16x16x32_bf16 v[216:219], v[196:199], v[180:183], v[216:219]
  ds_read_b64_tr_b16 v[172:173], v250 offset:5144
  ds_read_b64_tr_b16 v[174:175], v250 offset:6424
  v_mfma_f32_16x16x32_bf16 v[236:239], v[196:199], v[184:187], v[236:239]
  ds_read_b64_tr_b16 v[176:177], v250 offset:5152
  ds_read_b64_tr_b16 v[178:179], v250 offset:6432
  v_mfma_f32_16x16x32_bf16 v[220:223], v[200:203], v[180:183], v[220:223]
  s_add_u32 s55, s33, 5
  s_cmp_ge_u32 s55, 10
  s_cselect_b32 s56, 10, 0
  v_mfma_f32_16x16x32_bf16 v[240:243], v[200:203], v[184:187], v[240:243]
  s_sub_u32 s55, s55, s56
  s_lshl_b32 s55, s55, 12
  s_add_u32 s55, s55, 117760
  v_mfma_f32_16x16x32_bf16 v[224:227], v[204:207], v[180:183], v[224:227]
  s_add_u32 s56, s62, 50176
  s_cmp_eq_u32 s6, s70
  s_cselect_b32 s55, s55, s56
  v_mfma_f32_16x16x32_bf16 v[244:247], v[204:207], v[184:187], v[244:247]
  v_add_u32 v248, s55, v10
  v_xor_b32 v249, 64, v248
  s_waitcnt lgkmcnt(0)
  s_barrier
  v_mfma_f32_16x16x32_bf16 v[208:211], v[108:111], v[100:103], v[208:211]
  ds_read_b128 v[180:183], v248 offset:0
  ds_read_b128 v[184:187], v248 offset:2048
  v_mfma_f32_16x16x32_bf16 v[228:231], v[108:111], v[104:107], v[228:231]
  ds_read_b64_tr_b16 v[188:189], v250 offset:22528
  ds_read_b64_tr_b16 v[190:191], v250 offset:23808
  v_mfma_f32_16x16x32_bf16 v[212:215], v[112:115], v[100:103], v[212:215]
  ds_read_b64_tr_b16 v[192:193], v250 offset:22536
  ds_read_b64_tr_b16 v[194:195], v250 offset:23816
  v_mfma_f32_16x16x32_bf16 v[232:235], v[112:115], v[104:107], v[232:235]
  ds_read_b64_tr_b16 v[196:197], v250 offset:22544
  ds_read_b64_tr_b16 v[198:199], v250 offset:23824
  v_mfma_f32_16x16x32_bf16 v[216:219], v[116:119], v[100:103], v[216:219]
  ds_read_b64_tr_b16 v[200:201], v250 offset:22552
  ds_read_b64_tr_b16 v[202:203], v250 offset:23832
  v_mfma_f32_16x16x32_bf16 v[236:239], v[116:119], v[104:107], v[236:239]
  ds_read_b64_tr_b16 v[204:205], v250 offset:22560
  ds_read_b64_tr_b16 v[206:207], v250 offset:23840
  v_mfma_f32_16x16x32_bf16 v[220:223], v[120:123], v[100:103], v[220:223]
  v_mfma_f32_16x16x32_bf16 v[240:243], v[120:123], v[104:107], v[240:243]
  v_mfma_f32_16x16x32_bf16 v[224:227], v[124:127], v[100:103], v[224:227]
  v_mfma_f32_16x16x32_bf16 v[244:247], v[124:127], v[104:107], v[244:247]
  s_waitcnt lgkmcnt(3)
  v_mfma_f32_16x16x32_bf16 v[208:211], v[160:163], v[152:155], v[208:211]
  ds_read_b128 v[100:103], v249 offset:0
  ds_read_b128 v[104:107], v249 offset:2048
  v_mfma_f32_16x16x32_bf16 v[228:231], v[160:163], v[156:159], v[228:231]
  ds_read_b64_tr_b16 v[108:109], v250 offset:27648
  ds_read_b64_tr_b16 v[110:111], v250 offset:28928
  v_mfma_f32_16x16x32_bf16 v[212:215], v[164:167], v[152:155], v[212:215]
  ds_read_b64_tr_b16 v[112:113], v250 offset:27656
  ds_read_b64_tr_b16 v[114:115], v250 offset:28936
  v_mfma_f32_16x16x32_bf16 v[232:235], v[164:167], v[156:159], v[232:235]
  ds_read_b64_tr_b16 v[116:117], v250 offset:27664
  ds_read_b64_tr_b16 v[118:119], v250 offset:28944
  v_mfma_f32_16x16x32_bf16 v[216:219], v[168:171], v[152:155], v[216:219]
  ds_read_b64_tr_b16 v[120:121], v250 offset:27672
  ds_read_b64_tr_b16 v[122:123], v250 offset:28952
  v_mfma_f32_16x16x32_bf16 v[236:239], v[168:171], v[156:159], v[236:239]
  ds_read_b64_tr_b16 v[124:125], v250 offset:27680
  ds_read_b64_tr_b16 v[126:127], v250 offset:28960
  v_mfma_f32_16x16x32_bf16 v[220:223], v[172:175], v[152:155], v[220:223]
  s_add_u32 s55, s33, 6
  s_cmp_ge_u32 s55, 10
  s_cselect_b32 s56, 10, 0
  v_mfma_f32_16x16x32_bf16 v[240:243], v[172:175], v[156:159], v[240:243]
  s_sub_u32 s55, s55, s56
  s_lshl_b32 s55, s55, 12
  s_add_u32 s55, s55, 117760
  v_mfma_f32_16x16x32_bf16 v[224:227], v[176:179], v[152:155], v[224:227]
  s_add_u32 s56, s62, 72704
  s_cmp_eq_u32 s6, s70
  s_cselect_b32 s55, s55, s56
  v_mfma_f32_16x16x32_bf16 v[244:247], v[176:179], v[156:159], v[244:247]
  v_add_u32 v248, s55, v10
  v_xor_b32 v249, 64, v248
  s_waitcnt lgkmcnt(0)
  s_barrier
  v_mfma_f32_16x16x32_bf16 v[208:211], v[188:191], v[180:183], v[208:211]
  ds_read_b128 v[152:155], v248 offset:0
  ds_read_b128 v[156:159], v248 offset:2048
  v_mfma_f32_16x16x32_bf16 v[228:231], v[188:191], v[184:187], v[228:231]
  ds_read_b64_tr_b16 v[160:161], v251 offset:0
  ds_read_b64_tr_b16 v[162:163], v251 offset:1280
  v_mfma_f32_16x16x32_bf16 v[212:215], v[192:195], v[180:183], v[212:215]
  ds_read_b64_tr_b16 v[164:165], v251 offset:8
  ds_read_b64_tr_b16 v[166:167], v251 offset:1288
  v_mfma_f32_16x16x32_bf16 v[232:235], v[192:195], v[184:187], v[232:235]
  ds_read_b64_tr_b16 v[168:169], v251 offset:16
  ds_read_b64_tr_b16 v[170:171], v251 offset:1296
  v_mfma_f32_16x16x32_bf16 v[216:219], v[196:199], v[180:183], v[216:219]
  ds_read_b64_tr_b16 v[172:173], v251 offset:24
  ds_read_b64_tr_b16 v[174:175], v251 offset:1304
  v_mfma_f32_16x16x32_bf16 v[236:239], v[196:199], v[184:187], v[236:239]
  ds_read_b64_tr_b16 v[176:177], v251 offset:32
  ds_read_b64_tr_b16 v[178:179], v251 offset:1312
  v_mfma_f32_16x16x32_bf16 v[220:223], v[200:203], v[180:183], v[220:223]
  v_mfma_f32_16x16x32_bf16 v[240:243], v[200:203], v[184:187], v[240:243]
  v_mfma_f32_16x16x32_bf16 v[224:227], v[204:207], v[180:183], v[224:227]
  v_mfma_f32_16x16x32_bf16 v[244:247], v[204:207], v[184:187], v[244:247]
  s_waitcnt lgkmcnt(3)
  v_mfma_f32_16x16x32_bf16 v[208:211], v[108:111], v[100:103], v[208:211]
  ds_read_b128 v[180:183], v249 offset:0
  ds_read_b128 v[184:187], v249 offset:2048
  v_mfma_f32_16x16x32_bf16 v[228:231], v[108:111], v[104:107], v[228:231]
  ds_read_b64_tr_b16 v[188:189], v251 offset:5120
  ds_read_b64_tr_b16 v[190:191], v251 offset:6400
  v_mfma_f32_16x16x32_bf16 v[212:215], v[112:115], v[100:103], v[212:215]
  ds_read_b64_tr_b16 v[192:193], v251 offset:5128
  ds_read_b64_tr_b16 v[194:195], v251 offset:6408
  v_mfma_f32_16x16x32_bf16 v[232:235], v[112:115], v[104:107], v[232:235]
  ds_read_b64_tr_b16 v[196:197], v251 offset:5136
  ds_read_b64_tr_b16 v[198:199], v251 offset:6416
  v_mfma_f32_16x16x32_bf16 v[216:219], v[116:119], v[100:103], v[216:219]
  ds_read_b64_tr_b16 v[200:201], v251 offset:5144
  ds_read_b64_tr_b16 v[202:203], v251 offset:6424
  v_mfma_f32_16x16x32_bf16 v[236:239], v[116:119], v[104:107], v[236:239]
  ds_read_b64_tr_b16 v[204:205], v251 offset:5152
  ds_read_b64_tr_b16 v[206:207], v251 offset:6432
  v_mfma_f32_16x16x32_bf16 v[220:223], v[120:123], v[100:103], v[220:223]
  s_add_u32 s55, s33, 7
  s_cmp_ge_u32 s55, 10
  s_cselect_b32 s56, 10, 0
  v_mfma_f32_16x16x32_bf16 v[240:243], v[120:123], v[104:107], v[240:243]
  s_sub_u32 s55, s55, s56
  s_lshl_b32 s55, s55, 12
  s_add_u32 s55, s55, 117760
  v_mfma_f32_16x16x32_bf16 v[224:227], v[124:127], v[100:103], v[224:227]
  s_add_u32 s56, s62, 95232
  s_cmp_eq_u32 s6, s70
  s_cselect_b32 s55, s55, s56
  v_mfma_f32_16x16x32_bf16 v[244:247], v[124:127], v[104:107], v[244:247]
  v_add_u32 v248, s55, v10
  v_xor_b32 v249, 64, v248
  s_waitcnt lgkmcnt(0)
  s_barrier
  v_mfma_f32_16x16x32_bf16 v[208:211], v[160:163], v[152:155], v[208:211]
  ds_read_b128 v[100:103], v248 offset:0
  ds_read_b128 v[104:107], v248 offset:2048
  v_mfma_f32_16x16x32_bf16 v[228:231], v[160:163], v[156:159], v[228:231]
  ds_read_b64_tr_b16 v[108:109], v251 offset:22528
  ds_read_b64_tr_b16 v[110:111], v251 offset:23808
  v_mfma_f32_16x16x32_bf16 v[212:215], v[164:167], v[152:155], v[212:215]
  ds_read_b64_tr_b16 v[112:113], v251 offset:22536
  ds_read_b64_tr_b16 v[114:115], v251 offset:23816
  v_mfma_f32_16x16x32_bf16 v[232:235], v[164:167], v[156:159], v[232:235]
  ds_read_b64_tr_b16 v[116:117], v251 offset:22544
  ds_read_b64_tr_b16 v[118:119], v251 offset:23824
  v_mfma_f32_16x16x32_bf16 v[216:219], v[168:171], v[152:155], v[216:219]
  ds_read_b64_tr_b16 v[120:121], v251 offset:22552
  ds_read_b64_tr_b16 v[122:123], v251 offset:23832
  v_mfma_f32_16x16x32_bf16 v[236:239], v[168:171], v[156:159], v[236:239]
  ds_read_b64_tr_b16 v[124:125], v251 offset:22560
  ds_read_b64_tr_b16 v[126:127], v251 offset:23840
  v_mfma_f32_16x16x32_bf16 v[220:223], v[172:175], v[152:155], v[220:223]
  v_mfma_f32_16x16x32_bf16 v[240:243], v[172:175], v[156:159], v[240:243]
  v_mfma_f32_16x16x32_bf16 v[224:227], v[176:179], v[152:155], v[224:227]
  v_mfma_f32_16x16x32_bf16 v[244:247], v[176:179], v[156:159], v[244:247]
  s_waitcnt lgkmcnt(3)
  v_mfma_f32_16x16x32_bf16 v[208:211], v[188:191], v[180:183], v[208:211]
  ds_read_b128 v[152:155], v249 offset:0
  ds_read_b128 v[156:159], v249 offset:2048
  v_mfma_f32_16x16x32_bf16 v[228:231], v[188:191], v[184:187], v[228:231]
  ds_read_b64_tr_b16 v[160:161], v251 offset:27648
  ds_read_b64_tr_b16 v[162:163], v251 offset:28928
  v_mfma_f32_16x16x32_bf16 v[212:215], v[192:195], v[180:183], v[212:215]
  ds_read_b64_tr_b16 v[164:165], v251 offset:27656
  ds_read_b64_tr_b16 v[166:167], v251 offset:28936
  v_mfma_f32_16x16x32_bf16 v[232:235], v[192:195], v[184:187], v[232:235]
  ds_read_b64_tr_b16 v[168:169], v251 offset:27664
  ds_read_b64_tr_b16 v[170:171], v251 offset:28944
  v_mfma_f32_16x16x32_bf16 v[216:219], v[196:199], v[180:183], v[216:219]
  ds_read_b64_tr_b16 v[172:173], v251 offset:27672
  ds_read_b64_tr_b16 v[174:175], v251 offset:28952
  v_mfma_f32_16x16x32_bf16 v[236:239], v[196:199], v[184:187], v[236:239]
  ds_read_b64_tr_b16 v[176:177], v251 offset:27680
  ds_read_b64_tr_b16 v[178:179], v251 offset:28960
  v_mfma_f32_16x16x32_bf16 v[220:223], v[200:203], v[180:183], v[220:223]
  s_add_u32 s55, s33, 8
  s_cmp_ge_u32 s55, 10
  s_cselect_b32 s56, 10, 0
  v_mfma_f32_16x16x32_bf16 v[240:243], v[200:203], v[184:187], v[240:243]
  s_sub_u32 s55, s55, s56
  s_lshl_b32 s55, s55, 12
  s_add_u32 s55, s55, 117760
  v_mfma_f32_16x16x32_bf16 v[224:227], v[204:207], v[180:183], v[224:227]
  s_add_u32 s56, s62, 27648
  s_cmp_eq_u32 s6, s70
  s_cselect_b32 s55, s55, s56
  v_mfma_f32_16x16x32_bf16 v[244:247], v[204:207], v[184:187], v[244:247]
  v_add_u32 v248, s55, v10
  v_xor_b32 v249, 64, v248
  s_waitcnt lgkmcnt(0)
  s_barrier
  v_mfma_f32_16x16x32_bf16 v[208:211], v[108:111], v[100:103], v[208:211]
  ds_read_b128 v[180:183], v248 offset:0
  ds_read_b128 v[184:187], v248 offset:2048
  v_mfma_f32_16x16x32_bf16 v[228:231], v[108:111], v[104:107], v[228:231]
  ds_read_b64_tr_b16 v[188:189], v250 offset:0
  ds_read_b64_tr_b16 v[190:191], v250 offset:1280
  v_mfma_f32_16x16x32_bf16 v[212:215], v[112:115], v[100:103], v[212:215]
  ds_read_b64_tr_b16 v[192:193], v250 offset:8
  ds_read_b64_tr_b16 v[194:195], v250 offset:1288
  v_mfma_f32_16x16x32_bf16 v[232:235], v[112:115], v[104:107], v[232:235]
  ds_read_b64_tr_b16 v[196:197], v250 offset:16
  ds_read_b64_tr_b16 v[198:199], v250 offset:1296
  v_mfma_f32_16x16x32_bf16 v[216:219], v[116:119], v[100:103], v[216:219]
  ds_read_b64_tr_b16 v[200:201], v250 offset:24
  ds_read_b64_tr_b16 v[202:203], v250 offset:1304
  v_mfma_f32_16x16x32_bf16 v[236:239], v[116:119], v[104:107], v[236:239]
  ds_read_b64_tr_b16 v[204:205], v250 offset:32
  ds_read_b64_tr_b16 v[206:207], v250 offset:1312
  v_mfma_f32_16x16x32_bf16 v[220:223], v[120:123], v[100:103], v[220:223]
  v_mfma_f32_16x16x32_bf16 v[240:243], v[120:123], v[104:107], v[240:243]
  v_mfma_f32_16x16x32_bf16 v[224:227], v[124:127], v[100:103], v[224:227]
  v_mfma_f32_16x16x32_bf16 v[244:247], v[124:127], v[104:107], v[244:247]
  s_waitcnt lgkmcnt(3)
  v_mfma_f32_16x16x32_bf16 v[208:211], v[160:163], v[152:155], v[208:211]
  ds_read_b128 v[100:103], v249 offset:0
  ds_read_b128 v[104:107], v249 offset:2048
  v_mfma_f32_16x16x32_bf16 v[228:231], v[160:163], v[156:159], v[228:231]
  ds_read_b64_tr_b16 v[108:109], v250 offset:5120
  ds_read_b64_tr_b16 v[110:111], v250 offset:6400
  v_mfma_f32_16x16x32_bf16 v[212:215], v[164:167], v[152:155], v[212:215]
  ds_read_b64_tr_b16 v[112:113], v250 offset:5128
  ds_read_b64_tr_b16 v[114:115], v250 offset:6408
  v_mfma_f32_16x16x32_bf16 v[232:235], v[164:167], v[156:159], v[232:235]
  ds_read_b64_tr_b16 v[116:117], v250 offset:5136
  ds_read_b64_tr_b16 v[118:119], v250 offset:6416
  v_mfma_f32_16x16x32_bf16 v[216:219], v[168:171], v[152:155], v[216:219]
  ds_read_b64_tr_b16 v[120:121], v250 offset:5144
  ds_read_b64_tr_b16 v[122:123], v250 offset:6424
  v_mfma_f32_16x16x32_bf16 v[236:239], v[168:171], v[156:159], v[236:239]
  ds_read_b64_tr_b16 v[124:125], v250 offset:5152
  ds_read_b64_tr_b16 v[126:127], v250 offset:6432
  v_mfma_f32_16x16x32_bf16 v[220:223], v[172:175], v[152:155], v[220:223]
  s_add_u32 s55, s33, 9
  s_cmp_ge_u32 s55, 10
  s_cselect_b32 s56, 10, 0
  v_mfma_f32_16x16x32_bf16 v[240:243], v[172:175], v[156:159], v[240:243]
  s_sub_u32 s55, s55, s56
  s_lshl_b32 s55, s55, 12
  s_add_u32 s55, s55, 117760
  v_mfma_f32_16x16x32_bf16 v[224:227], v[176:179], v[152:155], v[224:227]
  s_add_u32 s56, s62, 50176
  s_cmp_eq_u32 s6, s70
  s_cselect_b32 s55, s55, s56
  v_mfma_f32_16x16x32_bf16 v[244:247], v[176:179], v[156:159], v[244:247]
  v_add_u32 v248, s55, v10
  v_xor_b32 v249, 64, v248
  s_waitcnt lgkmcnt(0)
  s_barrier
  v_mfma_f32_16x16x32_bf16 v[208:211], v[188:191], v[180:183], v[208:211]
  ds_read_b128 v[152:155], v248 offset:0
  ds_read_b128 v[156:159], v248 offset:2048
  v_mfma_f32_16x16x32_bf16 v[228:231], v[188:191], v[184:187], v[228:231]
  ds_read_b64_tr_b16 v[160:161], v250 offset:22528
  ds_read_b64_tr_b16 v[162:163], v250 offset:23808
  v_mfma_f32_16x16x32_bf16 v[212:215], v[192:195], v[180:183], v[212:215]
  ds_read_b64_tr_b16 v[164:165], v250 offset:22536
  ds_read_b64_tr_b16 v[166:167], v250 offset:23816
  v_mfma_f32_16x16x32_bf16 v[232:235], v[192:195], v[184:187], v[232:235]
  ds_read_b64_tr_b16 v[168:169], v250 offset:22544
  ds_read_b64_tr_b16 v[170:171], v250 offset:23824
  v_mfma_f32_16x16x32_bf16 v[216:219], v[196:199], v[180:183], v[216:219]
  ds_read_b64_tr_b16 v[172:173], v250 offset:22552
  ds_read_b64_tr_b16 v[174:175], v250 offset:23832
  v_mfma_f32_16x16x32_bf16 v[236:239], v[196:199], v[184:187], v[236:239]
  ds_read_b64_tr_b16 v[176:177], v250 offset:22560
  ds_read_b64_tr_b16 v[178:179], v250 offset:23840
  v_mfma_f32_16x16x32_bf16 v[220:223], v[200:203], v[180:183], v[220:223]
  v_mfma_f32_16x16x32_bf16 v[240:243], v[200:203], v[184:187], v[240:243]
  v_mfma_f32_16x16x32_bf16 v[224:227], v[204:207], v[180:183], v[224:227]
  v_mfma_f32_16x16x32_bf16 v[244:247], v[204:207], v[184:187], v[244:247]
  s_waitcnt lgkmcnt(3)
  v_mfma_f32_16x16x32_bf16 v[208:211], v[108:111], v[100:103], v[208:211]
  ds_read_b128 v[180:183], v249 offset:0
  ds_read_b128 v[184:187], v249 offset:2048
  v_mfma_f32_16x16x32_bf16 v[228:231], v[108:111], v[104:107], v[228:231]
  ds_read_b64_tr_b16 v[188:189], v250 offset:27648
  ds_read_b64_tr_b16 v[190:191], v250 offset:28928
  v_mfma_f32_16x16x32_bf16 v[212:215], v[112:115], v[100:103], v[212:215]
  ds_read_b64_tr_b16 v[192:193], v250 offset:27656
  ds_read_b64_tr_b16 v[194:195], v250 offset:28936
  v_mfma_f32_16x16x32_bf16 v[232:235], v[112:115], v[104:107], v[232:235]
  ds_read_b64_tr_b16 v[196:197], v250 offset:27664
  ds_read_b64_tr_b16 v[198:199], v250 offset:28944
  v_mfma_f32_16x16x32_bf16 v[216:219], v[116:119], v[100:103], v[216:219]
  ds_read_b64_tr_b16 v[200:201], v250 offset:27672
  ds_read_b64_tr_b16 v[202:203], v250 offset:28952
  v_mfma_f32_16x16x32_bf16 v[236:239], v[116:119], v[104:107], v[236:239]
  ds_read_b64_tr_b16 v[204:205], v250 offset:27680
  ds_read_b64_tr_b16 v[206:207], v250 offset:28960
  v_mfma_f32_16x16x32_bf16 v[220:223], v[120:123], v[100:103], v[220:223]
  v_mfma_f32_16x16x32_bf16 v[240:243], v[120:123], v[104:107], v[240:243]
  v_mfma_f32_16x16x32_bf16 v[224:227], v[124:127], v[100:103], v[224:227]
  v_mfma_f32_16x16x32_bf16 v[244:247], v[124:127], v[104:107], v[244:247]
  s_waitcnt lgkmcnt(12)
  v_mfma_f32_16x16x32_bf16 v[208:211], v[160:163], v[152:155], v[208:211]
  v_mfma_f32_16x16x32_bf16 v[212:215], v[164:167], v[152:155], v[212:215]
  v_mfma_f32_16x16x32_bf16 v[216:219], v[168:171], v[152:155], v[216:219]
  v_mfma_f32_16x16x32_bf16 v[220:223], v[172:175], v[152:155], v[220:223]
  v_mfma_f32_16x16x32_bf16 v[224:227], v[176:179], v[152:155], v[224:227]
  v_mfma_f32_16x16x32_bf16 v[228:231], v[160:163], v[156:159], v[228:231]
  v_mfma_f32_16x16x32_bf16 v[232:235], v[164:167], v[156:159], v[232:235]
  v_mfma_f32_16x16x32_bf16 v[236:239], v[168:171], v[156:159], v[236:239]
  v_mfma_f32_16x16x32_bf16 v[240:243], v[172:175], v[156:159], v[240:243]
  v_mfma_f32_16x16x32_bf16 v[244:247], v[176:179], v[156:159], v[244:247]
  s_waitcnt lgkmcnt(0)
  v_mfma_f32_16x16x32_bf16 v[208:211], v[188:191], v[180:183], v[208:211]
  v_mfma_f32_16x16x32_bf16 v[212:215], v[192:195], v[180:183], v[212:215]
  v_mfma_f32_16x16x32_bf16 v[216:219], v[196:199], v[180:183], v[216:219]
  v_mfma_f32_16x16x32_bf16 v[220:223], v[200:203], v[180:183], v[220:223]
  v_mfma_f32_16x16x32_bf16 v[224:227], v[204:207], v[180:183], v[224:227]
  v_mfma_f32_16x16x32_bf16 v[228:231], v[188:191], v[184:187], v[228:231]
  s_nop 2
  v_cvt_pk_bf16_f32 v100, v208, v209
  v_cvt_pk_bf16_f32 v101, v210, v211
  v_mfma_f32_16x16x32_bf16 v[232:235], v[192:195], v[184:187], v[232:235]
  v_cvt_pk_bf16_f32 v102, v212, v213
  v_cvt_pk_bf16_f32 v103, v214, v215
  ds_write_b128 v12, v[100:103] offset:0
  v_mfma_f32_16x16x32_bf16 v[236:239], v[196:199], v[184:187], v[236:239]
  v_cvt_pk_bf16_f32 v104, v216, v217
  v_cvt_pk_bf16_f32 v105, v218, v219
  v_mfma_f32_16x16x32_bf16 v[240:243], v[200:203], v[184:187], v[240:243]
  v_cvt_pk_bf16_f32 v106, v220, v221
  v_cvt_pk_bf16_f32 v107, v222, v223
  ds_write_b128 v12, v[104:107] offset:512
  v_mfma_f32_16x16x32_bf16 v[244:247], v[204:207], v[184:187], v[244:247]
  v_cvt_pk_bf16_f32 v108, v224, v225
  v_cvt_pk_bf16_f32 v109, v226, v227
  ds_write_b64 v13, v[108:109] offset:1024
  v_cvt_pk_bf16_f32 v112, v228, v229
  v_cvt_pk_bf16_f32 v113, v230, v231
  v_cvt_pk_bf16_f32 v114, v232, v233
  v_cvt_pk_bf16_f32 v115, v234, v235
  ds_write_b128 v12, v[112:115] offset:256
  v_cvt_pk_bf16_f32 v116, v236, v237
  v_cvt_pk_bf16_f32 v117, v238, v239
  v_cvt_pk_bf16_f32 v118, v240, v241
  v_cvt_pk_bf16_f32 v119, v242, v243
  ds_write_b128 v12, v[116:119] offset:768
  v_cvt_pk_bf16_f32 v120, v244, v245
  v_cvt_pk_bf16_f32 v121, v246, v247
  ds_write_b64 v13, v[120:121] offset:1152
  s_branch L_ATT
L_LOADER:
  v_add_u32 v5, 0, v0
  v_mul_u32_u24 v6, 6554, v5
  v_lshrrev_b32 v6, 16, v6
  v_mul_u32_u24 v7, 10, v6
  v_sub_u32 v7, v5, v7
  v_and_b32 v5, 0x13, v6
  v_and_b32 v8, 4, v6
  v_lshl_or_b32 v5, v8, 1, v5
  v_and_b32 v8, 8, v6
  v_lshrrev_b32 v8, 1, v8
  v_or_b32 v5, v5, v8
  v_mul_u32_u24 v5, 1280, v5
  v_lshl_add_u32 v10, v7, 4, v5
  v_add_u32 v5, 64, v0
  v_mul_u32_u24 v6, 6554, v5
  v_lshrrev_b32 v6, 16, v6
  v_mul_u32_u24 v7, 10, v6
  v_sub_u32 v7, v5, v7
  v_and_b32 v5, 0x13, v6
  v_and_b32 v8, 4, v6
  v_lshl_or_b32 v5, v8, 1, v5
  v_and_b32 v8, 8, v6
  v_lshrrev_b32 v8, 1, v8
  v_or_b32 v5, v5, v8
  v_mul_u32_u24 v5, 1280, v5
  v_lshl_add_u32 v11, v7, 4, v5
  v_add_u32 v5, 128, v0
  v_mul_u32_u24 v6, 6554, v5
  v_lshrrev_b32 v6, 16, v6
  v_mul_u32_u24 v7, 10, v6
  v_sub_u32 v7, v5, v7
  v_and_b32 v5, 0x13, v6
  v_and_b32 v8, 4, v6
  v_lshl_or_b32 v5, v8, 1, v5
  v_and_b32 v8, 8, v6
  v_lshrrev_b32 v8, 1, v8
  v_or_b32 v5, v5, v8
  v_mul_u32_u24 v5, 1280, v5
  v_lshl_add_u32 v12, v7, 4, v5
  s_sub_u32 s7, s6, 4
  s_mul_i32 s49, s5, 160
  s_mul_i32 s54, s7, 20480
  s_add_u32 s49, s49, s54
  s_mul_i32 s54, s7, 3072
  s_mul_i32 s51, s7, 2560
  s_add_u32 s51, s51, 12288
  s_lshl_b32 s50, s7, 10
  s_lshl_b32 s53, s70, 2
  s_mul_i32 s55, s7, 3
  s_add_u32 s55, s55, 0
  s_cmp_ge_u32 s55, s53
  s_cselect_b32 s56, 4, 0
  s_add_u32 s55, s55, s56
  s_lshl_b32 s55, s55, 3
  s_add_u32 s55, s55, s48
  s_mul_i32 s40, s55, 1280
  s_mul_i32 s55, s7, 3
  s_add_u32 s55, s55, 1
  s_cmp_ge_u32 s55, s53
  s_cselect_b32 s56, 4, 0
  s_add_u32 s55, s55, s56
  s_lshl_b32 s55, s55, 3
  s_add_u32 s55, s55, s48
  s_mul_i32 s41, s55, 1280
  s_mul_i32 s55, s7, 3
  s_add_u32 s55, s55, 2
  s_cmp_ge_u32 s55, s53
  s_cselect_b32 s56, 4, 0
  s_add_u32 s55, s55, s56
  s_lshl_b32 s55, s55, 3
  s_add_u32 s55, s55, s48
  s_mul_i32 s42, s55, 1280
  s_waitcnt lgkmcnt(0)
  s_cmp_eq_u32 s3, 0
  s_cselect_b32 s72, s10, s16
  s_cselect_b32 s73, s11, s17
  s_mov_b32 s74, 819200
  s_mov_b32 s75, 0x00020000
  s_mov_b32 s36, s8
  s_mov_b32 s37, s9
  s_mov_b32 s38, 2621440
  s_mov_b32 s39, 0x00020000
  s_mov_b32 s28, s24
  s_mov_b32 s29, s25
  s_mov_b32 s30, 7237888
  s_mov_b32 s31, 0x00020000
  s_and_b32 s15, s6, 3
  s_lshl_b32 s13, s4, 2
  s_add_u32 s12, s15, s13
  s_lshr_b32 s13, s6, 2
  s_mul_i32 s15, s15, 5120
  s_mul_i32 s14, s13, 2560
  s_add_u32 s15, s15, s14
  s_add_u32 s15, s15, 95232
  v_and_b32 v38, 31, v0
  v_lshrrev_b32 v39, 5, v0
  v_lshlrev_b32 v89, 3, v38
  v_lshl_add_u32 v89, v39, 2, v89
  v_add_u32 v91, s15, v3
  v_add_u32 v92, s15, v89
  v_mul_u32_u24 v90, 20, v39
  v_add_lshl_u32 v90, v90, v38, 4
  s_mul_i32 s26, s12, 81920
  s_lshl_b32 s14, s13, 1
  s_add_u32 s14, s14, s3
  s_lshl_b32 s14, s14, 3
  s_add_u32 s14, s14, s5
  s_mul_i32 s14, s14, 1280
  s_add_u32 s26, s26, s14
  s_add_u32 s26, s26, 344064
  v_lshrrev_b32 v30, 4, v38
  v_mul_u32_u24 v30, 40960, v30
  v_lshl_add_u32 v30, v39, 8, v30
  v_and_b32 v88, 15, v0
  v_lshl_add_u32 v30, v88, 4, v30
  s_mul_i32 s14, s3, 163840
  v_add_u32 v31, s14, v3
  s_lshl_b32 s14, s3, 6
  s_add_u32 s14, s14, s12
  s_lshl_b32 s14, s14, 7
  s_add_u32 s14, s14, 327680
  v_mov_b32 v29, 0x3f803f80
  v_mov_b32 v40, 0
  v_mov_b32 v41, 0
  v_mov_b32 v42, 0
  v_mov_b32 v43, 0
  v_mov_b32 v44, 0
  v_mov_b32 v45, 0
  v_mov_b32 v46, 0
  v_mov_b32 v47, 0
  v_mov_b32 v37, 0x3f803f80
  v_mov_b32 v48, 0
  v_mov_b32 v49, 0
  v_mov_b32 v50, 0
  v_mov_b32 v51, 0
  v_mov_b32 v52, 0
  v_mov_b32 v53, 0
  v_mov_b32 v54, 0
  v_mov_b32 v55, 0
  s_mov_b32 exec_lo, 0x01100000
  s_mov_b32 exec_hi, 0x01100000
  v_mov_b32 v40, 0x3f803f80
  v_mov_b32 v41, 0x3f803f80
  v_mov_b32 v42, 0x3f803f80
  v_mov_b32 v43, 0x3f803f80
  v_mov_b32 v44, 0x3f803f80
  v_mov_b32 v45, 0x3f803f80
  v_mov_b32 v46, 0x3f803f80
  v_mov_b32 v47, 0x3f803f80
  v_mov_b32 v48, 0x3f803f80
  v_mov_b32 v49, 0x3f803f80
  v_mov_b32 v50, 0x3f803f80
  v_mov_b32 v51, 0x3f803f80
  v_mov_b32 v52, 0x3f803f80
  v_mov_b32 v53, 0x3f803f80
  v_mov_b32 v54, 0x3f803f80
  v_mov_b32 v55, 0x3f803f80
  s_mov_b64 exec, -1
  v_mov_b32 v56, 0
  v_mov_b32 v57, 0
  v_mov_b32 v58, 0
  v_mov_b32 v59, 0
  v_mov_b32 v60, 0
  v_mov_b32 v61, 0
  v_mov_b32 v62, 0
  v_mov_b32 v63, 0
  v_mov_b32 v64, 0
  v_mov_b32 v65, 0
  v_mov_b32 v66, 0
  v_mov_b32 v67, 0
  v_mov_b32 v68, 0
  v_mov_b32 v69, 0
  v_mov_b32 v70, 0
  v_mov_b32 v71, 0
  v_mov_b32 v72, 0
  v_mov_b32 v73, 0
  v_mov_b32 v74, 0
  v_mov_b32 v75, 0
  v_mov_b32 v76, 0
  v_mov_b32 v77, 0
  v_mov_b32 v78, 0
  v_mov_b32 v79, 0
  v_mov_b32 v80, 0
  v_mov_b32 v81, 0
  v_mov_b32 v82, 0
  v_mov_b32 v83, 0
  v_mov_b32 v84, 0
  v_mov_b32 v85, 0
  v_mov_b32 v86, 0
  v_mov_b32 v87, 0
  v_mov_b32 v136, 0
  v_mov_b32 v137, 0
  v_mov_b32 v138, 0
  v_mov_b32 v139, 0
  v_mov_b32 v140, 0
  v_mov_b32 v141, 0
  v_mov_b32 v142, 0
  v_mov_b32 v143, 0
  v_mov_b32 v144, 0
  v_mov_b32 v145, 0
  v_mov_b32 v146, 0
  v_mov_b32 v147, 0
  v_mov_b32 v148, 0
  v_mov_b32 v149, 0
  v_mov_b32 v150, 0
  v_mov_b32 v151, 0
  v_mov_b32 v218, 0
  v_mov_b32 v219, 0
  v_mov_b32 v228, 0
  v_mov_b32 v229, 0
  s_cmp_eq_u32 s6, 5
  s_cbranch_scc0 L_NORL
  s_lshr_b32 s56, s2, 3
  s_and_b32 s35, s56, 7
  s_lshl_b32 s35, s35, 1
  s_lshr_b32 s57, s2, 7
  s_add_u32 s35, s35, s57
  s_mul_i32 s35, s35, 51200
  s_mul_i32 s56, s56, 5
  s_and_b32 s57, s2, 7
  s_mul_i32 s32, s57, 160
  s_add_u32 s32, s32, s35
  v_mul_u32_u24 v227, 6554, v0
  v_lshrrev_b32 v227, 16, v227
  v_mul_u32_u24 v216, 10, v227
  v_sub_u32 v216, v0, v216
  v_lshrrev_b32 v184, 1, v227
  v_mul_u32_u24 v184, 20, v184
  v_and_b32 v185, 1, v227
  v_lshl_add_u32 v184, v185, 2, v184
  v_cmp_eq_u32 vcc, 4, v227
  v_mov_b32 v185, 8
  s_nop 0
  v_cndmask_b32 v184, v184, 16, vcc
  v_cndmask_b32 v185, v185, 20, vcc
  v_add_u32 v185, v184, v185
  v_mul_u32_u24 v184, 1280, v184
  v_mul_u32_u24 v185, 1280, v185
  v_lshl_add_u32 v228, v216, 4, v184
  v_lshl_add_u32 v229, v216, 4, v185
  v_cmp_lt_u32 vcc, 7, v216
  v_lshrrev_b32 v184, 2, v216
  v_mul_u32_u24 v184, 81920, v184
  v_lshl_add_u32 v184, v227, 8, v184
  v_and_b32 v185, 3, v216
  v_lshlrev_b32 v186, 1, v185
  v_cndmask_b32 v185, v185, v186, vcc
  v_lshl_add_u32 v218, v185, 6, v184
  v_mov_b32 v185, 40960
  v_cndmask_b32 v185, v185, 64, vcc
  v_add_u32 v219, v218, v185
  s_mul_i32 s35, s57, 204800
  s_lshl_b32 s56, s56, 8
  s_add_u32 s35, s35, s56
  s_add_u32 s35, s35, 5586944
L_NORL:
  v_lshlrev_b32 v13, 7, v38
  s_lshl_b32 s57, s3, 12
  s_add_u32 s57, s57, 7225600
  s_add_u32 s55, s33, 0
  s_cmp_ge_u32 s55, 10
  s_cselect_b32 s56, 10, 0
  s_sub_u32 s55, s55, s56
  s_mul_i32 s55, s55, 81920
  s_add_u32 s55, s55, s49
  s_add_u32 m0, s51, 27648
  s_nop 0
  buffer_load_dwordx4 v10, s[72:75], s55 offen lds
  s_add_u32 m0, s51, 28672
  s_nop 0
  buffer_load_dwordx4 v11, s[72:75], s55 offen lds
  s_add_u32 m0, s51, 29696
  s_mov_b32 exec_hi, 0
  buffer_load_dwordx4 v12, s[72:75], s55 offen lds
  s_mov_b32 exec_hi, -1
  s_add_u32 s55, s33, 1
  s_cmp_ge_u32 s55, 10
  s_cselect_b32 s56, 10, 0
  s_sub_u32 s55, s55, s56
  s_mul_i32 s55, s55, 81920
  s_add_u32 s55, s55, s49
  s_add_u32 m0, s51, 50176
  s_nop 0
  buffer_load_dwordx4 v10, s[72:75], s55 offen lds
  s_add_u32 m0, s51, 51200
  s_nop 0
  buffer_load_dwordx4 v11, s[72:75], s55 offen lds
  s_add_u32 m0, s51, 52224
  s_mov_b32 exec_hi, 0
  buffer_load_dwordx4 v12, s[72:75], s55 offen lds
  s_mov_b32 exec_hi, -1
  s_mov_b32 s53, 7225344
  buffer_load_dword v9, v4, s[28:31], s53 offen sc1
  s_barrier
  s_add_u32 s55, s33, 2
  s_cmp_ge_u32 s55, 10
  s_cselect_b32 s56, 10, 0
  s_sub_u32 s55, s55, s56
  s_mul_i32 s55, s55, 81920
  s_add_u32 s55, s55, s49
  s_add_u32 m0, s51, 72704
  s_nop 0
  buffer_load_dwordx4 v10, s[72:75], s55 offen lds
  s_add_u32 m0, s51, 73728
  s_nop 0
  buffer_load_dwordx4 v11, s[72:75], s55 offen lds
  s_add_u32 m0, s51, 74752
  s_mov_b32 exec_hi, 0
  buffer_load_dwordx4 v12, s[72:75], s55 offen lds
  s_mov_b32 exec_hi, -1
  s_add_u32 s55, s33, 0
  s_cmp_ge_u32 s55, 10
  s_cselect_b32 s56, 10, 0
  s_sub_u32 s55, s55, s56
  s_lshl_b32 s55, s55, 7
  s_add_u32 m0, s54, 27648
  s_add_u32 s56, s55, s40
  buffer_load_dwordx4 v2, s[36:39], s56 offen lds
  s_add_u32 m0, s54, 28672
  s_add_u32 s56, s55, s41
  buffer_load_dwordx4 v2, s[36:39], s56 offen lds
  s_add_u32 m0, s54, 29696
  s_add_u32 s56, s55, s42
  buffer_load_dwordx4 v2, s[36:39], s56 offen lds
  s_add_u32 s55, s33, 1
  s_cmp_ge_u32 s55, 10
  s_cselect_b32 s56, 10, 0
  s_sub_u32 s55, s55, s56
  s_lshl_b32 s55, s55, 7
  s_add_u32 m0, s54, 50176
  s_add_u32 s56, s55, s40
  buffer_load_dwordx4 v2, s[36:39], s56 offen lds
  s_add_u32 m0, s54, 51200
  s_add_u32 s56, s55, s41
  buffer_load_dwordx4 v2, s[36:39], s56 offen lds
  s_add_u32 m0, s54, 52224
  s_add_u32 s56, s55, s42
  buffer_load_dwordx4 v2, s[36:39], s56 offen lds
  s_add_u32 s55, s33, 2
  s_cmp_ge_u32 s55, 10
  s_cselect_b32 s56, 10, 0
  s_sub_u32 s55, s55, s56
  s_lshl_b32 s55, s55, 7
  s_add_u32 m0, s54, 72704
  s_add_u32 s56, s55, s40
  buffer_load_dwordx4 v2, s[36:39], s56 offen lds
  s_add_u32 m0, s54, 73728
  s_add_u32 s56, s55, s41
  buffer_load_dwordx4 v2, s[36:39], s56 offen lds
  s_add_u32 m0, s54, 74752
  s_add_u32 s56, s55, s42
  buffer_load_dwordx4 v2, s[36:39], s56 offen lds
  s_waitcnt vmcnt(6)
  s_barrier
  v_readfirstlane_b32 s34, v9
  s_add_u32 s55, s33, 3
  s_cmp_ge_u32 s55, 10
  s_cselect_b32 s56, 10, 0
  s_sub_u32 s55, s55, s56
  s_mul_i32 s55, s55, 81920
  s_add_u32 s55, s55, s49
  s_add_u32 m0, s51, 95232
  s_nop 0
  buffer_load_dwordx4 v10, s[72:75], s55 offen lds
  s_add_u32 m0, s51, 96256
  s_nop 0
  buffer_load_dwordx4 v11, s[72:75], s55 offen lds
  s_add_u32 m0, s51, 97280
  s_mov_b32 exec_hi, 0
  buffer_load_dwordx4 v12, s[72:75], s55 offen lds
  s_mov_b32 exec_hi, -1
  s_add_u32 s55, s33, 3
  s_cmp_ge_u32 s55, 10
  s_cselect_b32 s56, 10, 0
  s_sub_u32 s55, s55, s56
  s_lshl_b32 s55, s55, 7
  s_add_u32 m0, s54, 95232
  s_add_u32 s56, s55, s40
  buffer_load_dwordx4 v2, s[36:39], s56 offen lds
  s_add_u32 m0, s54, 96256
  s_add_u32 s56, s55, s41
  buffer_load_dwordx4 v2, s[36:39], s56 offen lds
  s_add_u32 m0, s54, 97280
  s_add_u32 s56, s55, s42
  buffer_load_dwordx4 v2, s[36:39], s56 offen lds
  s_waitcnt vmcnt(9)
  s_barrier
  s_mul_i32 s34, s34, 0x9e3779b1
  s_add_u32 s34, s34, 0x7f4a7c15
  s_add_u32 s55, s33, 4
  s_cmp_ge_u32 s55, 10
  s_cselect_b32 s56, 10, 0
  s_sub_u32 s55, s55, s56
  s_mul_i32 s55, s55, 81920
  s_add_u32 s55, s55, s49
  s_add_u32 m0, s51, 27648
  s_nop 0
  buffer_load_dwordx4 v10, s[72:75], s55 offen lds
  s_add_u32 m0, s51, 28672
  s_nop 0
  buffer_load_dwordx4 v11, s[72:75], s55 offen lds
  s_add_u32 m0, s51, 29696
  s_mov_b32 exec_hi, 0
  buffer_load_dwordx4 v12, s[72:75], s55 offen lds
  s_mov_b32 exec_hi, -1
  s_add_u32 s55, s33, 4
  s_cmp_ge_u32 s55, 10
  s_cselect_b32 s56, 10, 0
  s_sub_u32 s55, s55, s56
  s_lshl_b32 s55, s55, 7
  s_add_u32 m0, s54, 27648
  s_add_u32 s56, s55, s40
  buffer_load_dwordx4 v2, s[36:39], s56 offen lds
  s_add_u32 m0, s54, 28672
  s_add_u32 s56, s55, s41
  buffer_load_dwordx4 v2, s[36:39], s56 offen lds
  s_add_u32 m0, s54, 29696
  s_add_u32 s56, s55, s42
  buffer_load_dwordx4 v2, s[36:39], s56 offen lds
  s_waitcnt vmcnt(12)
  s_barrier
  s_add_u32 s55, s33, 5
  s_cmp_ge_u32 s55, 10
  s_cselect_b32 s56, 10, 0
  s_sub_u32 s55, s55, s56
  s_mul_i32 s55, s55, 81920
  s_add_u32 s55, s55, s49
  s_add_u32 m0, s51, 50176
  s_nop 0
  buffer_load_dwordx4 v10, s[72:75], s55 offen lds
  s_add_u32 m0, s51, 51200
  s_nop 0
  buffer_load_dwordx4 v11, s[72:75], s55 offen lds
  s_add_u32 m0, s51, 52224
  s_mov_b32 exec_hi, 0
  buffer_load_dwordx4 v12, s[72:75], s55 offen lds
  s_mov_b32 exec_hi, -1
  s_add_u32 s55, s33, 5
  s_cmp_ge_u32 s55, 10
  s_cselect_b32 s56, 10, 0
  s_sub_u32 s55, s55, s56
  s_lshl_b32 s55, s55, 7
  s_add_u32 m0, s54, 50176
  s_add_u32 s56, s55, s40
  buffer_load_dwordx4 v2, s[36:39], s56 offen lds
  s_add_u32 m0, s54, 51200
  s_add_u32 s56, s55, s41
  buffer_load_dwordx4 v2, s[36:39], s56 offen lds
  s_add_u32 m0, s54, 52224
  s_add_u32 s56, s55, s42
  buffer_load_dwordx4 v2, s[36:39], s56 offen lds
  s_waitcnt vmcnt(12)
  s_barrier
  s_add_u32 s55, s33, 6
  s_cmp_ge_u32 s55, 10
  s_cselect_b32 s56, 10, 0
  s_sub_u32 s55, s55, s56
  s_mul_i32 s55, s55, 81920
  s_add_u32 s55, s55, s49
  s_add_u32 m0, s51, 72704
  s_nop 0
  buffer_load_dwordx4 v10, s[72:75], s55 offen lds
  s_add_u32 m0, s51, 73728
  s_nop 0
  buffer_load_dwordx4 v11, s[72:75], s55 offen lds
  s_add_u32 m0, s51, 74752
  s_mov_b32 exec_hi, 0
  buffer_load_dwordx4 v12, s[72:75], s55 offen lds
  s_mov_b32 exec_hi, -1
  s_add_u32 s55, s33, 6
  s_cmp_ge_u32 s55, 10
  s_cselect_b32 s56, 10, 0
  s_sub_u32 s55, s55, s56
  s_lshl_b32 s55, s55, 7
  s_add_u32 m0, s54, 72704
  s_add_u32 s56, s55, s40
  buffer_load_dwordx4 v2, s[36:39], s56 offen lds
  s_add_u32 m0, s54, 73728
  s_add_u32 s56, s55, s41
  buffer_load_dwordx4 v2, s[36:39], s56 offen lds
  s_add_u32 m0, s54, 74752
  s_add_u32 s56, s55, s42
  buffer_load_dwordx4 v2, s[36:39], s56 offen lds
  s_waitcnt vmcnt(12)
  s_barrier
  s_add_u32 s55, s33, 7
  s_cmp_ge_u32 s55, 10
  s_cselect_b32 s56, 10, 0
  s_sub_u32 s55, s55, s56
  s_mul_i32 s55, s55, 81920
  s_add_u32 s55, s55, s49
  s_add_u32 m0, s51, 95232
  s_nop 0
  buffer_load_dwordx4 v10, s[72:75], s55 offen lds
  s_add_u32 m0, s51, 96256
  s_nop 0
  buffer_load_dwordx4 v11, s[72:75], s55 offen lds
  s_add_u32 m0, s51, 97280
  s_mov_b32 exec_hi, 0
  buffer_load_dwordx4 v12, s[72:75], s55 offen lds
  s_mov_b32 exec_hi, -1
  s_add_u32 s55, s33, 7
  s_cmp_ge_u32 s55, 10
  s_cselect_b32 s56, 10, 0
  s_sub_u32 s55, s55, s56
  s_lshl_b32 s55, s55, 7
  s_add_u32 m0, s54, 95232
  s_add_u32 s56, s55, s40
  buffer_load_dwordx4 v2, s[36:39], s56 offen lds
  s_add_u32 m0, s54, 96256
  s_add_u32 s56, s55, s41
  buffer_load_dwordx4 v2, s[36:39], s56 offen lds
  s_add_u32 m0, s54, 97280
  s_add_u32 s56, s55, s42
  buffer_load_dwordx4 v2, s[36:39], s56 offen lds
  s_cmp_eq_u32 s6, 4
  s_cselect_b32 exec_lo, -1, 1
  s_mov_b32 exec_hi, 0
  buffer_load_dwordx4 v[16:19], v13, s[28:31], s57 offen sc1
  s_mov_b64 exec, -1
  s_waitcnt vmcnt(13)
  s_barrier
  s_add_u32 s55, s33, 8
  s_cmp_ge_u32 s55, 10
  s_cselect_b32 s56, 10, 0
  s_sub_u32 s55, s55, s56
  s_mul_i32 s55, s55, 81920
  s_add_u32 s55, s55, s49
  s_add_u32 m0, s51, 27648
  s_nop 0
  buffer_load_dwordx4 v10, s[72:75], s55 offen lds
  s_add_u32 m0, s51, 28672
  s_nop 0
  buffer_load_dwordx4 v11, s[72:75], s55 offen lds
  s_add_u32 m0, s51, 29696
  s_mov_b32 exec_hi, 0
  buffer_load_dwordx4 v12, s[72:75], s55 offen lds
  s_mov_b32 exec_hi, -1
  s_add_u32 s55, s33, 8
  s_cmp_ge_u32 s55, 10
  s_cselect_b32 s56, 10, 0
  s_sub_u32 s55, s55, s56
  s_lshl_b32 s55, s55, 7
  s_add_u32 m0, s54, 27648
  s_add_u32 s56, s55, s40
  buffer_load_dwordx4 v2, s[36:39], s56 offen lds
  s_add_u32 m0, s54, 28672
  s_add_u32 s56, s55, s41
  buffer_load_dwordx4 v2, s[36:39], s56 offen lds
  s_add_u32 m0, s54, 29696
  s_add_u32 s56, s55, s42
  buffer_load_dwordx4 v2, s[36:39], s56 offen lds
  s_waitcnt vmcnt(13)
  s_barrier
  s_add_u32 s55, s33, 9
  s_cmp_ge_u32 s55, 10
  s_cselect_b32 s56, 10, 0
  s_sub_u32 s55, s55, s56
  s_mul_i32 s55, s55, 81920
  s_add_u32 s55, s55, s49
  s_add_u32 m0, s51, 50176
  s_nop 0
  buffer_load_dwordx4 v10, s[72:75], s55 offen lds
  s_add_u32 m0, s51, 51200
  s_nop 0
  buffer_load_dwordx4 v11, s[72:75], s55 offen lds
  s_add_u32 m0, s51, 52224
  s_mov_b32 exec_hi, 0
  buffer_load_dwordx4 v12, s[72:75], s55 offen lds
  s_mov_b32 exec_hi, -1
  s_add_u32 s55, s33, 9
  s_cmp_ge_u32 s55, 10
  s_cselect_b32 s56, 10, 0
  s_sub_u32 s55, s55, s56
  s_lshl_b32 s55, s55, 7
  s_add_u32 m0, s54, 50176
  s_add_u32 s56, s55, s40
  buffer_load_dwordx4 v2, s[36:39], s56 offen lds
  s_add_u32 m0, s54, 51200
  s_add_u32 s56, s55, s41
  buffer_load_dwordx4 v2, s[36:39], s56 offen lds
  s_add_u32 m0, s54, 52224
  s_add_u32 s56, s55, s42
  buffer_load_dwordx4 v2, s[36:39], s56 offen lds
  s_waitcnt vmcnt(13)
  s_barrier
  s_cmp_eq_u32 s6, 4
  s_cbranch_scc0 L_N4
  s_mov_b32 exec_hi, 0
  s_waitcnt vmcnt(12)
  v_cmp_ne_u32 vcc, s34, v16
  v_cmp_ne_u32 s[58:59], s34, v17
  s_or_b64 vcc, vcc, s[58:59]
  v_cmp_ne_u32 s[58:59], s34, v18
  s_or_b64 vcc, vcc, s[58:59]
  v_cmp_ne_u32 s[58:59], s34, v19
  s_or_b64 vcc, vcc, s[58:59]
  s_mov_b32 exec_hi, -1
  s_cmp_eq_u64 vcc, 0
  s_cbranch_scc1 L_EARLY
  s_waitcnt vmcnt(6)
  s_barrier
  s_waitcnt vmcnt(0)
  s_barrier
  s_mov_b32 s20, -1
  s_mov_b32 s21, 0
  s_mov_b32 s60, 200000
  s_mov_b64 exec, s[20:21]
L_PKV_ld:
  buffer_load_dwordx4 v[16:19], v13, s[28:31], s57 offen sc1
L_PKV_chk:
  s_waitcnt vmcnt(0)
  v_cmp_ne_u32 vcc, s34, v16
  v_cmp_ne_u32 s[58:59], s34, v17
  s_or_b64 vcc, vcc, s[58:59]
  v_cmp_ne_u32 s[58:59], s34, v18
  s_or_b64 vcc, vcc, s[58:59]
  v_cmp_ne_u32 s[58:59], s34, v19
  s_or_b64 vcc, vcc, s[58:59]
  s_sub_u32 s60, s60, 1
  s_cbranch_scc1 L_PKV_ok
  s_cmp_eq_u64 vcc, 0
  s_cbranch_scc1 L_PKV_ok
  s_sleep 1
  s_branch L_PKV_ld
L_PKV_ok:
  s_mov_b64 exec, -1
  s_mov_b32 m0, 0
  s_mov_b32 s20, 0
  buffer_load_dwordx4 v31, s[28:31], s20 offen sc1 lds
  s_mov_b32 m0, 1024
  s_mov_b32 s20, 1024
  buffer_load_dwordx4 v31, s[28:31], s20 offen sc1 lds
  s_mov_b32 m0, 2048
  s_mov_b32 s20, 2048
  buffer_load_dwordx4 v31, s[28:31], s20 offen sc1 lds
  s_mov_b32 m0, 3072
  s_mov_b32 s20, 3072
  buffer_load_dwordx4 v31, s[28:31], s20 offen sc1 lds
  s_mov_b32 m0, 4096
  s_mov_b32 s20, 4096
  buffer_load_dwordx4 v31, s[28:31], s20 offen sc1 lds
  s_mov_b32 m0, 5120
  s_mov_b32 s20, 5120
  buffer_load_dwordx4 v31, s[28:31], s20 offen sc1 lds
  s_mov_b32 m0, 6144
  s_mov_b32 s20, 6144
  buffer_load_dwordx4 v31, s[28:31], s20 offen sc1 lds
  s_mov_b32 m0, 7168
  s_mov_b32 s20, 7168
  buffer_load_dwordx4 v31, s[28:31], s20 offen sc1 lds
  s_mov_b32 m0, 8192
  s_mov_b32 s20, 8192
  buffer_load_dwordx4 v31, s[28:31], s20 offen sc1 lds
  s_mov_b32 m0, 9216
  s_mov_b32 s20, 9216
  buffer_load_dwordx4 v31, s[28:31], s20 offen sc1 lds
  s_mov_b32 m0, 10240
  s_mov_b32 s20, 10240
  buffer_load_dwordx4 v31, s[28:31], s20 offen sc1 lds
  s_mov_b32 m0, 11264
  s_mov_b32 s20, 11264
  buffer_load_dwordx4 v31, s[28:31], s20 offen sc1 lds
  s_mov_b32 m0, 12288
  s_mov_b32 s20, 12288
  buffer_load_dwordx4 v31, s[28:31], s20 offen sc1 lds
  s_mov_b32 m0, 13312
  s_mov_b32 s20, 13312
  buffer_load_dwordx4 v31, s[28:31], s20 offen sc1 lds
  s_mov_b32 m0, 14336
  s_mov_b32 s20, 14336
  buffer_load_dwordx4 v31, s[28:31], s20 offen sc1 lds
  s_mov_b32 m0, 15360
  s_mov_b32 s20, 15360
  buffer_load_dwordx4 v31, s[28:31], s20 offen sc1 lds
  s_mov_b32 m0, 16384
  s_mov_b32 s20, 16384
  buffer_load_dwordx4 v31, s[28:31], s20 offen sc1 lds
  s_mov_b32 m0, 17408
  s_mov_b32 s20, 17408
  buffer_load_dwordx4 v31, s[28:31], s20 offen sc1 lds
  s_mov_b32 m0, 18432
  s_mov_b32 s20, 18432
  buffer_load_dwordx4 v31, s[28:31], s20 offen sc1 lds
  s_mov_b32 m0, 19456
  s_mov_b32 s20, 19456
  buffer_load_dwordx4 v31, s[28:31], s20 offen sc1 lds
  s_mov_b32 m0, 20480
  s_mov_b32 s20, 20480
  buffer_load_dwordx4 v31, s[28:31], s20 offen sc1 lds
  s_mov_b32 m0, 21504
  s_mov_b32 s20, 21504
  buffer_load_dwordx4 v31, s[28:31], s20 offen sc1 lds
  s_mov_b32 m0, 22528
  s_mov_b32 s20, 22528
  buffer_load_dwordx4 v31, s[28:31], s20 offen sc1 lds
  s_mov_b32 m0, 23552
  s_mov_b32 s20, 23552
  buffer_load_dwordx4 v31, s[28:31], s20 offen sc1 lds
  s_mov_b32 m0, 24576
  s_mov_b32 s20, 24576
  buffer_load_dwordx4 v31, s[28:31], s20 offen sc1 lds
  s_branch L_LATE
L_EARLY:
  s_mov_b32 m0, 0
  s_mov_b32 s20, 0
  buffer_load_dwordx4 v31, s[28:31], s20 offen sc1 lds
  s_mov_b32 m0, 1024
  s_mov_b32 s20, 1024
  buffer_load_dwordx4 v31, s[28:31], s20 offen sc1 lds
  s_mov_b32 m0, 2048
  s_mov_b32 s20, 2048
  buffer_load_dwordx4 v31, s[28:31], s20 offen sc1 lds
  s_mov_b32 m0, 3072
  s_mov_b32 s20, 3072
  buffer_load_dwordx4 v31, s[28:31], s20 offen sc1 lds
  s_mov_b32 m0, 4096
  s_mov_b32 s20, 4096
  buffer_load_dwordx4 v31, s[28:31], s20 offen sc1 lds
  s_mov_b32 m0, 5120
  s_mov_b32 s20, 5120
  buffer_load_dwordx4 v31, s[28:31], s20 offen sc1 lds
  s_mov_b32 m0, 6144
  s_mov_b32 s20, 6144
  buffer_load_dwordx4 v31, s[28:31], s20 offen sc1 lds
  s_mov_b32 m0, 7168
  s_mov_b32 s20, 7168
  buffer_load_dwordx4 v31, s[28:31], s20 offen sc1 lds
  s_mov_b32 m0, 8192
  s_mov_b32 s20, 8192
  buffer_load_dwordx4 v31, s[28:31], s20 offen sc1 lds
  s_mov_b32 m0, 9216
  s_mov_b32 s20, 9216
  buffer_load_dwordx4 v31, s[28:31], s20 offen sc1 lds
  s_waitcnt vmcnt(16)
  s_barrier
  s_mov_b32 m0, 10240
  s_mov_b32 s20, 10240
  buffer_load_dwordx4 v31, s[28:31], s20 offen sc1 lds
  s_mov_b32 m0, 11264
  s_mov_b32 s20, 11264
  buffer_load_dwordx4 v31, s[28:31], s20 offen sc1 lds
  s_mov_b32 m0, 12288
  s_mov_b32 s20, 12288
  buffer_load_dwordx4 v31, s[28:31], s20 offen sc1 lds
  s_mov_b32 m0, 13312
  s_mov_b32 s20, 13312
  buffer_load_dwordx4 v31, s[28:31], s20 offen sc1 lds
  s_mov_b32 m0, 14336
  s_mov_b32 s20, 14336
  buffer_load_dwordx4 v31, s[28:31], s20 offen sc1 lds
  s_mov_b32 m0, 15360
  s_mov_b32 s20, 15360
  buffer_load_dwordx4 v31, s[28:31], s20 offen sc1 lds
  s_mov_b32 m0, 16384
  s_mov_b32 s20, 16384
  buffer_load_dwordx4 v31, s[28:31], s20 offen sc1 lds
  s_mov_b32 m0, 17408
  s_mov_b32 s20, 17408
  buffer_load_dwordx4 v31, s[28:31], s20 offen sc1 lds
  s_mov_b32 m0, 18432
  s_mov_b32 s20, 18432
  buffer_load_dwordx4 v31, s[28:31], s20 offen sc1 lds
  s_mov_b32 m0, 19456
  s_mov_b32 s20, 19456
  buffer_load_dwordx4 v31, s[28:31], s20 offen sc1 lds
  s_mov_b32 m0, 20480
  s_mov_b32 s20, 20480
  buffer_load_dwordx4 v31, s[28:31], s20 offen sc1 lds
  s_mov_b32 m0, 21504
  s_mov_b32 s20, 21504
  buffer_load_dwordx4 v31, s[28:31], s20 offen sc1 lds
  s_mov_b32 m0, 22528
  s_mov_b32 s20, 22528
  buffer_load_dwordx4 v31, s[28:31], s20 offen sc1 lds
  s_mov_b32 m0, 23552
  s_mov_b32 s20, 23552
  buffer_load_dwordx4 v31, s[28:31], s20 offen sc1 lds
  s_mov_b32 m0, 24576
  s_mov_b32 s20, 24576
  buffer_load_dwordx4 v31, s[28:31], s20 offen sc1 lds
  s_waitcnt vmcnt(25)
  s_barrier
L_LATE:
  s_waitcnt vmcnt(20)
  s_branch L_ATT
L_N4:
  s_waitcnt vmcnt(6)
  s_barrier
  s_waitcnt vmcnt(0)
  s_barrier
L_ATT:
  v_mov_b32 v2, v89
  v_mov_b32 v1, v90
  v_mov_b32 v10, 0xdddddddd
  v_mov_b32 v9, 0
  v_mov_b32 v17, 0
  v_lshlrev_b32 v20, 2, v38
  s_mov_b32 s36, 0x000fffff
  s_mov_b32 s37, 0x000fffff
  s_mov_b32 s38, 0
  s_mov_b32 s39, -1
  s_mov_b32 s42, 1
  s_mul_i32 s43, s13, 3
  s_cmp_eq_u32 s13, 0
  s_cselect_b32 s45, 24, 112
  s_or_b32 s45, s45, 256
  s_mov_b32 s44, 8
  s_waitcnt lgkmcnt(0)
  s_barrier
  ds_read_b128 v[4:7], v91
  ds_read_b32 v8, v92 offset:1024
  ds_read_b128 v[12:15], v91 offset:1280
  ds_read_b32 v16, v92 offset:2304
  ds_read_b128 v[24:27], v3 offset:0
  ds_read_b32 v28, v2 offset:1024
  ds_read_b128 v[32:35], v3 offset:2560
  ds_read_b32 v36, v2 offset:3584
  s_mov_b64 exec, s[36:37]
  ds_read_b128 v[48:51], v1 offset:1280
  ds_read_b128 v[52:55], v1 offset:1920
  s_mov_b64 exec, -1
  buffer_load_dword v11, v20, s[28:31], s14 offen sc1
  s_waitcnt lgkmcnt(4)
  s_cmp_eq_u32 s13, 0
  s_cbranch_scc1 L_BQ2
  s_waitcnt vmcnt(1)
  s_barrier
L_BQ2:
  v_mfma_f32_32x32x16_bf16 v[120:135], v[24:27], v[4:7], 0
  v_mfma_f32_32x32x8_bf16 v[88:103], v[28:29], v[8:9], v[120:135]
  v_mfma_f32_32x32x16_bf16 v[104:119], v[24:27], v[12:15], 0
  v_mfma_f32_32x32x8_bf16 v[104:119], v[28:29], v[16:17], v[104:119]
  s_cbranch_scc0 L_BQ3
  s_setprio 2
  s_barrier
L_BQ3:
  s_nop 8
  v_max3_f32 v22, v88, v89, v90
  v_max3_f32 v20, v91, v92, v93
  v_max3_f32 v22, v94, v95, v22
  v_max3_f32 v20, v96, v97, v20
  v_max3_f32 v22, v98, v99, v22
  v_max3_f32 v20, v100, v101, v20
  v_max3_f32 v22, v102, v103, v22
  v_max_f32 v22, v22, v20
  v_mov_b32 v20, v22
  s_nop 1
  v_permlane32_swap_b32 v22, v20
  s_nop 0
  v_min_f32 v22, -v22, -v20
  v_lshrrev_b32 v22, 16, v22
  v_cndmask_b32 v9, v22, 0, s[38:39]
  v_max3_f32 v23, v104, v105, v106
  v_max3_f32 v21, v107, v108, v109
  v_mfma_f32_32x32x8_bf16 v[88:103], v[28:29], v[8:9], v[120:135]
  v_max3_f32 v23, v110, v111, v23
  v_max3_f32 v21, v112, v113, v21
  v_max3_f32 v23, v114, v115, v23
  v_max3_f32 v21, v116, v117, v21
  v_max3_f32 v23, v118, v119, v23
  v_max_f32 v23, v23, v21
  v_mov_b32 v21, v23
  s_nop 1
  v_permlane32_swap_b32 v23, v21
  s_nop 0
  v_min_f32 v23, -v23, -v21
  v_lshrrev_b32 v23, 16, v23
  v_cndmask_b32 v17, v23, 0, s[38:39]
  s_cmp_eq_u32 s13, 0
  s_cbranch_scc0 L_LAG0
  s_setprio 2
  s_waitcnt lgkmcnt(0)
  s_branch L_PR
L_LAG0:
  s_add_u32 m0, s50, 24576
  s_add_u32 s20, s50, 24576
  buffer_load_dwordx4 v31, s[28:31], s20 offen sc1 lds
  s_add_u32 m0, s50, 28672
  s_add_u32 s20, s50, 28672
  buffer_load_dwordx4 v31, s[28:31], s20 offen sc1 lds
  s_add_u32 m0, s50, 32768
  s_add_u32 s20, s50, 32768
  buffer_load_dwordx4 v31, s[28:31], s20 offen sc1 lds
  s_add_u32 m0, s50, 36864
  s_add_u32 s20, s50, 36864
  buffer_load_dwordx4 v31, s[28:31], s20 offen sc1 lds
  s_add_u32 m0, s50, 40960
  s_add_u32 s20, s50, 40960
  buffer_load_dwordx4 v31, s[28:31], s20 offen sc1 lds
  s_add_u32 m0, s50, 45056
  s_add_u32 s20, s50, 45056
  buffer_load_dwordx4 v31, s[28:31], s20 offen sc1 lds
  s_add_u32 m0, s50, 49152
  s_add_u32 s20, s50, 49152
  buffer_load_dwordx4 v31, s[28:31], s20 offen sc1 lds
  s_add_u32 m0, s50, 53248
  s_add_u32 s20, s50, 53248
  buffer_load_dwordx4 v31, s[28:31], s20 offen sc1 lds
  s_add_u32 m0, s50, 57344
  s_add_u32 s20, s50, 57344
  buffer_load_dwordx4 v31, s[28:31], s20 offen sc1 lds
  s_add_u32 m0, s50, 61440
  s_add_u32 s20, s50, 61440
  buffer_load_dwordx4 v31, s[28:31], s20 offen sc1 lds
  s_add_u32 m0, s50, 65536
  s_add_u32 s20, s50, 65536
  buffer_load_dwordx4 v31, s[28:31], s20 offen sc1 lds
  s_add_u32 m0, s50, 69632
  s_add_u32 s20, s50, 69632
  buffer_load_dwordx4 v31, s[28:31], s20 offen sc1 lds
  s_add_u32 m0, s50, 73728
  s_add_u32 s20, s50, 73728
  buffer_load_dwordx4 v31, s[28:31], s20 offen sc1 lds
  s_add_u32 m0, s50, 77824
  s_add_u32 s20, s50, 77824
  buffer_load_dwordx4 v31, s[28:31], s20 offen sc1 lds
  s_add_u32 m0, s50, 81920
  s_add_u32 s20, s50, 81920
  buffer_load_dwordx4 v31, s[28:31], s20 offen sc1 lds
  s_add_u32 m0, s50, 86016
  s_add_u32 s20, s50, 86016
  buffer_load_dwordx4 v31, s[28:31], s20 offen sc1 lds
  s_add_u32 m0, s50, 90112
  s_add_u32 s20, s50, 90112
  buffer_load_dwordx4 v31, s[28:31], s20 offen sc1 lds
  s_add_u32 m0, s50, 94208
  s_add_u32 s20, s50, 94208
  buffer_load_dwordx4 v31, s[28:31], s20 offen sc1 lds
  s_add_u32 m0, s50, 98304
  s_add_u32 s20, s50, 98304
  buffer_load_dwordx4 v31, s[28:31], s20 offen sc1 lds
  s_add_u32 m0, s50, 102400
  s_add_u32 s20, s50, 102400
  buffer_load_dwordx4 v31, s[28:31], s20 offen sc1 lds
  s_add_u32 m0, s50, 106496
  s_add_u32 s20, s50, 106496
  buffer_load_dwordx4 v31, s[28:31], s20 offen sc1 lds
  s_add_u32 m0, s50, 110592
  s_add_u32 s20, s50, 110592
  buffer_load_dwordx4 v31, s[28:31], s20 offen sc1 lds
  s_add_u32 m0, s50, 114688
  s_add_u32 s20, s50, 114688
  buffer_load_dwordx4 v31, s[28:31], s20 offen sc1 lds
  s_add_u32 m0, s50, 118784
  s_add_u32 s20, s50, 118784
  buffer_load_dwordx4 v31, s[28:31], s20 offen sc1 lds
  s_add_u32 m0, s50, 122880
  s_add_u32 s20, s50, 122880
  buffer_load_dwordx4 v31, s[28:31], s20 offen sc1 lds
  s_add_u32 m0, s50, 126976
  s_add_u32 s20, s50, 126976
  buffer_load_dwordx4 v31, s[28:31], s20 offen sc1 lds
  s_add_u32 m0, s50, 131072
  s_add_u32 s20, s50, 131072
  buffer_load_dwordx4 v31, s[28:31], s20 offen sc1 lds
  s_add_u32 m0, s50, 135168
  s_add_u32 s20, s50, 135168
  buffer_load_dwordx4 v31, s[28:31], s20 offen sc1 lds
  s_add_u32 m0, s50, 139264
  s_add_u32 s20, s50, 139264
  buffer_load_dwordx4 v31, s[28:31], s20 offen sc1 lds
  s_add_u32 m0, s50, 143360
  s_add_u32 s20, s50, 143360
  buffer_load_dwordx4 v31, s[28:31], s20 offen sc1 lds
  s_add_u32 m0, s50, 147456
  s_add_u32 s20, s50, 147456
  buffer_load_dwordx4 v31, s[28:31], s20 offen sc1 lds
  s_add_u32 m0, s50, 151552
  s_add_u32 s20, s50, 151552
  buffer_load_dwordx4 v31, s[28:31], s20 offen sc1 lds
  s_add_u32 m0, s50, 155648
  s_add_u32 s20, s50, 155648
  buffer_load_dwordx4 v31, s[28:31], s20 offen sc1 lds
  s_add_u32 m0, s50, 159744
  s_add_u32 s20, s50, 159744
  buffer_load_dwordx4 v31, s[28:31], s20 offen sc1 lds
  s_cmp_eq_u32 s6, 5
  s_cbranch_scc0 L_POIS
  s_bitcmp0_b32 s2, 6
  s_cselect_b32 s72, s68, s22
  s_cselect_b32 s73, s69, s23
  s_mov_b32 s74, 819200
  s_mov_b32 s75, 0x00020000
  s_mov_b32 exec_hi, 0x3ffff
  buffer_load_dwordx4 v[152:155], v228, s[72:75], s32 offen offset:0
  buffer_load_dwordx4 v[156:159], v228, s[72:75], s32 offen offset:1280
  buffer_load_dwordx4 v[160:163], v228, s[72:75], s32 offen offset:2560
  buffer_load_dwordx4 v[164:167], v228, s[72:75], s32 offen offset:3840
  buffer_load_dwordx4 v[168:171], v229, s[72:75], s32 offen offset:0
  buffer_load_dwordx4 v[172:175], v229, s[72:75], s32 offen offset:1280
  buffer_load_dwordx4 v[176:179], v229, s[72:75], s32 offen offset:2560
  buffer_load_dwordx4 v[180:183], v229, s[72:75], s32 offen offset:3840
  s_branch L_S1
L_POIS:
  s_mul_i32 s55, s4, 327680
  s_lshl_b32 s56, s3, 3
  s_add_u32 s56, s56, s5
  s_mul_i32 s56, s56, 2560
  s_add_u32 s55, s55, s56
  s_add_u32 s55, s55, 344064
  s_sub_u32 s56, s6, 5
  s_max_i32 s56, s56, 0
  s_lshl_b32 s56, s56, 10
  s_add_u32 s55, s55, s56
  v_mov_b32 v252, -1
  v_mov_b32 v253, -1
  v_mov_b32 v254, -1
  v_mov_b32 v255, -1
  s_cmp_eq_u32 s6, 7
  s_cselect_b32 exec_hi, 0, -1
  buffer_store_dwordx4 v[252:255], v3, s[28:31], s55 offen sc1
  s_add_u32 s55, s55, 40960
  buffer_store_dwordx4 v[252:255], v3, s[28:31], s55 offen sc1
  s_add_u32 s55, s55, 40960
  buffer_store_dwordx4 v[252:255], v3, s[28:31], s55 offen sc1
  s_add_u32 s55, s55, 40960
  buffer_store_dwordx4 v[252:255], v3, s[28:31], s55 offen sc1
  s_add_u32 s55, s55, 40960
  buffer_store_dwordx4 v[252:255], v3, s[28:31], s55 offen sc1
  s_add_u32 s55, s55, 40960
  buffer_store_dwordx4 v[252:255], v3, s[28:31], s55 offen sc1
  s_add_u32 s55, s55, 40960
  buffer_store_dwordx4 v[252:255], v3, s[28:31], s55 offen sc1
  s_add_u32 s55, s55, 40960
  buffer_store_dwordx4 v[252:255], v3, s[28:31], s55 offen sc1
  s_add_u32 s55, s55, 40960
L_S1:
  s_mov_b64 exec, -1
  s_waitcnt vmcnt(8) lgkmcnt(0)
  s_barrier
  s_setprio 3
L_PR:
  .p2align 6
L_LOOP:
  v_mfma_f32_32x32x16_bf16 v[104:119], v[24:27], v[12:15], 0
  v_exp_f32 v88, v88
  v_exp_f32 v89, v89
  v_exp_f32 v90, v90
  v_exp_f32 v91, v91
  v_mfma_f32_32x32x8_bf16 v[104:119], v[28:29], v[16:17], v[104:119]
  v_exp_f32 v92, v92
  v_exp_f32 v93, v93
  v_exp_f32 v94, v94
  v_exp_f32 v95, v95
  v_smfmac_f32_32x32x32_bf16 v[72:87], v[40:43], v[136:143], v10
  v_exp_f32 v96, v96
  v_exp_f32 v97, v97
  v_exp_f32 v98, v98
  v_exp_f32 v99, v99
  v_smfmac_f32_32x32x32_bf16 v[72:87], v[44:47], v[144:151], v10
  v_exp_f32 v100, v100
  v_exp_f32 v101, v101
  v_exp_f32 v102, v102
  v_exp_f32 v103, v103
  s_waitcnt lgkmcnt(0)
  v_mfma_f32_32x32x16_bf16 v[120:135], v[32:35], v[4:7], 0
  v_exp_f32 v104, v104
  v_exp_f32 v105, v105
  ds_read_b128 v[24:27], v3 offset:5120
  ds_read_b32 v28, v2 offset:6144
  v_exp_f32 v106, v106
  v_exp_f32 v107, v107
  v_mfma_f32_32x32x8_bf16 v[120:135], v[36:37], v[8:9], v[120:135]
  v_exp_f32 v108, v108
  v_exp_f32 v109, v109
  s_mov_b64 exec, s[36:37]
  ds_read_b128 v[40:43], v1 offset:3840
  ds_read_b128 v[44:47], v1 offset:4480
  s_mov_b64 exec, -1
  v_exp_f32 v110, v110
  v_exp_f32 v111, v111
  v_smfmac_f32_32x32x32_bf16 v[56:71], v[48:51], v[88:95], v10
  v_exp_f32 v112, v112
  v_exp_f32 v113, v113
  v_exp_f32 v114, v114
  v_exp_f32 v115, v115
  v_smfmac_f32_32x32x32_bf16 v[56:71], v[52:55], v[96:103], v10
  v_exp_f32 v116, v116
  v_exp_f32 v117, v117
  v_exp_f32 v118, v118
  v_exp_f32 v119, v119
  v_mfma_f32_32x32x16_bf16 v[136:151], v[32:35], v[12:15], 0
  v_exp_f32 v120, v120
  v_exp_f32 v121, v121
  v_exp_f32 v122, v122
  v_exp_f32 v123, v123
  v_mfma_f32_32x32x8_bf16 v[136:151], v[36:37], v[16:17], v[136:151]
  v_exp_f32 v124, v124
  v_exp_f32 v125, v125
  v_exp_f32 v126, v126
  v_exp_f32 v127, v127
  v_smfmac_f32_32x32x32_bf16 v[72:87], v[48:51], v[104:111], v10
  v_exp_f32 v128, v128
  v_exp_f32 v129, v129
  v_exp_f32 v130, v130
  v_exp_f32 v131, v131
  v_smfmac_f32_32x32x32_bf16 v[72:87], v[52:55], v[112:119], v10
  v_exp_f32 v132, v132
  v_exp_f32 v133, v133
  v_exp_f32 v134, v134
  v_exp_f32 v135, v135
  s_waitcnt lgkmcnt(0)
  v_mfma_f32_32x32x16_bf16 v[88:103], v[24:27], v[4:7], 0
  v_exp_f32 v136, v136
  v_exp_f32 v137, v137
  ds_read_b128 v[32:35], v3 offset:7680
  ds_read_b32 v36, v2 offset:8704
  v_exp_f32 v138, v138
  v_exp_f32 v139, v139
  v_mfma_f32_32x32x8_bf16 v[88:103], v[28:29], v[8:9], v[88:103]
  v_exp_f32 v140, v140
  v_exp_f32 v141, v141
  s_mov_b64 exec, s[36:37]
  ds_read_b128 v[48:51], v1 offset:6400
  ds_read_b128 v[52:55], v1 offset:7040
  s_mov_b64 exec, -1
  v_exp_f32 v142, v142
  v_exp_f32 v143, v143
  v_smfmac_f32_32x32x32_bf16 v[56:71], v[40:43], v[120:127], v10
  v_exp_f32 v144, v144
  v_exp_f32 v145, v145
  v_exp_f32 v146, v146
  v_exp_f32 v147, v147
  v_smfmac_f32_32x32x32_bf16 v[56:71], v[44:47], v[128:135], v10
  v_exp_f32 v148, v148
  v_exp_f32 v149, v149
  v_exp_f32 v150, v150
  v_exp_f32 v151, v151
  s_cmp_eq_u32 s43, s44
  s_cbranch_scc0 L_PH
  s_setprio 1
L_PH:
  v_mfma_f32_32x32x16_bf16 v[104:119], v[24:27], v[12:15], 0
  v_exp_f32 v88, v88
  v_exp_f32 v89, v89
  v_exp_f32 v90, v90
  v_exp_f32 v91, v91
  v_mfma_f32_32x32x8_bf16 v[104:119], v[28:29], v[16:17], v[104:119]
  v_exp_f32 v92, v92
  v_exp_f32 v93, v93
  v_exp_f32 v94, v94
  v_exp_f32 v95, v95
  v_smfmac_f32_32x32x32_bf16 v[72:87], v[40:43], v[136:143], v10
  v_exp_f32 v96, v96
  v_exp_f32 v97, v97
  v_exp_f32 v98, v98
  v_exp_f32 v99, v99
  v_smfmac_f32_32x32x32_bf16 v[72:87], v[44:47], v[144:151], v10
  v_exp_f32 v100, v100
  v_exp_f32 v101, v101
  v_exp_f32 v102, v102
  v_exp_f32 v103, v103
  s_waitcnt lgkmcnt(0)
  v_mfma_f32_32x32x16_bf16 v[120:135], v[32:35], v[4:7], 0
  v_exp_f32 v104, v104
  v_exp_f32 v105, v105
  ds_read_b128 v[24:27], v3 offset:10240
  ds_read_b32 v28, v2 offset:11264
  v_exp_f32 v106, v106
  v_exp_f32 v107, v107
  v_mfma_f32_32x32x8_bf16 v[120:135], v[36:37], v[8:9], v[120:135]
  v_exp_f32 v108, v108
  v_exp_f32 v109, v109
  s_mov_b64 exec, s[36:37]
  ds_read_b128 v[40:43], v1 offset:8960
  ds_read_b128 v[44:47], v1 offset:9600
  s_mov_b64 exec, -1
  v_exp_f32 v110, v110
  v_exp_f32 v111, v111
  v_smfmac_f32_32x32x32_bf16 v[56:71], v[48:51], v[88:95], v10
  v_exp_f32 v112, v112
  v_exp_f32 v113, v113
  v_exp_f32 v114, v114
  v_exp_f32 v115, v115
  v_smfmac_f32_32x32x32_bf16 v[56:71], v[52:55], v[96:103], v10
  v_exp_f32 v116, v116
  v_exp_f32 v117, v117
  v_exp_f32 v118, v118
  v_exp_f32 v119, v119
  v_mfma_f32_32x32x16_bf16 v[136:151], v[32:35], v[12:15], 0
  v_exp_f32 v120, v120
  v_exp_f32 v121, v121
  v_exp_f32 v122, v122
  v_exp_f32 v123, v123
  v_mfma_f32_32x32x8_bf16 v[136:151], v[36:37], v[16:17], v[136:151]
  v_exp_f32 v124, v124
  v_exp_f32 v125, v125
  v_exp_f32 v126, v126
  v_exp_f32 v127, v127
  v_smfmac_f32_32x32x32_bf16 v[72:87], v[48:51], v[104:111], v10
  v_exp_f32 v128, v128
  v_exp_f32 v129, v129
  v_exp_f32 v130, v130
  v_exp_f32 v131, v131
  v_smfmac_f32_32x32x32_bf16 v[72:87], v[52:55], v[112:119], v10
  v_exp_f32 v132, v132
  v_exp_f32 v133, v133
  v_exp_f32 v134, v134
  v_exp_f32 v135, v135
  s_waitcnt lgkmcnt(0)
  v_mfma_f32_32x32x16_bf16 v[88:103], v[24:27], v[4:7], 0
  v_exp_f32 v136, v136
  v_exp_f32 v137, v137
  ds_read_b128 v[32:35], v3 offset:12800
  ds_read_b32 v36, v2 offset:13824
  v_exp_f32 v138, v138
  v_exp_f32 v139, v139
  v_mfma_f32_32x32x8_bf16 v[88:103], v[28:29], v[8:9], v[88:103]
  v_exp_f32 v140, v140
  v_exp_f32 v141, v141
  s_mov_b64 exec, s[36:37]
  ds_read_b128 v[48:51], v1 offset:11520
  ds_read_b128 v[52:55], v1 offset:12160
  s_mov_b64 exec, -1
  v_exp_f32 v142, v142
  v_exp_f32 v143, v143
  v_smfmac_f32_32x32x32_bf16 v[56:71], v[40:43], v[120:127], v10
  v_exp_f32 v144, v144
  v_exp_f32 v145, v145
  v_exp_f32 v146, v146
  v_exp_f32 v147, v147
  v_smfmac_f32_32x32x32_bf16 v[56:71], v[44:47], v[128:135], v10
  v_exp_f32 v148, v148
  v_exp_f32 v149, v149
  v_exp_f32 v150, v150
  v_exp_f32 v151, v151
  v_mfma_f32_32x32x16_bf16 v[104:119], v[24:27], v[12:15], 0
  v_exp_f32 v88, v88
  v_exp_f32 v89, v89
  v_exp_f32 v90, v90
  v_exp_f32 v91, v91
  v_mfma_f32_32x32x8_bf16 v[104:119], v[28:29], v[16:17], v[104:119]
  v_exp_f32 v92, v92
  v_exp_f32 v93, v93
  v_exp_f32 v94, v94
  v_exp_f32 v95, v95
  v_smfmac_f32_32x32x32_bf16 v[72:87], v[40:43], v[136:143], v10
  v_exp_f32 v96, v96
  v_exp_f32 v97, v97
  v_exp_f32 v98, v98
  v_exp_f32 v99, v99
  v_smfmac_f32_32x32x32_bf16 v[72:87], v[44:47], v[144:151], v10
  v_exp_f32 v100, v100
  v_exp_f32 v101, v101
  v_exp_f32 v102, v102
  v_exp_f32 v103, v103
  s_waitcnt lgkmcnt(0)
  v_mfma_f32_32x32x16_bf16 v[120:135], v[32:35], v[4:7], 0
  v_exp_f32 v104, v104
  v_exp_f32 v105, v105
  ds_read_b128 v[24:27], v3 offset:15360
  ds_read_b32 v28, v2 offset:16384
  v_exp_f32 v106, v106
  v_exp_f32 v107, v107
  v_mfma_f32_32x32x8_bf16 v[120:135], v[36:37], v[8:9], v[120:135]
  v_exp_f32 v108, v108
  v_exp_f32 v109, v109
  s_mov_b64 exec, s[36:37]
  ds_read_b128 v[40:43], v1 offset:14080
  ds_read_b128 v[44:47], v1 offset:14720
  s_mov_b64 exec, -1
  v_exp_f32 v110, v110
  v_exp_f32 v111, v111
  v_smfmac_f32_32x32x32_bf16 v[56:71], v[48:51], v[88:95], v10
  v_exp_f32 v112, v112
  v_exp_f32 v113, v113
  v_exp_f32 v114, v114
  v_exp_f32 v115, v115
  v_smfmac_f32_32x32x32_bf16 v[56:71], v[52:55], v[96:103], v10
  v_exp_f32 v116, v116
  v_exp_f32 v117, v117
  v_exp_f32 v118, v118
  v_exp_f32 v119, v119
  v_mfma_f32_32x32x16_bf16 v[136:151], v[32:35], v[12:15], 0
  v_exp_f32 v120, v120
  v_exp_f32 v121, v121
  v_exp_f32 v122, v122
  v_exp_f32 v123, v123
  v_mfma_f32_32x32x8_bf16 v[136:151], v[36:37], v[16:17], v[136:151]
  v_exp_f32 v124, v124
  v_exp_f32 v125, v125
  v_exp_f32 v126, v126
  v_exp_f32 v127, v127
  v_smfmac_f32_32x32x32_bf16 v[72:87], v[48:51], v[104:111], v10
  v_exp_f32 v128, v128
  v_exp_f32 v129, v129
  v_exp_f32 v130, v130
  v_exp_f32 v131, v131
  v_smfmac_f32_32x32x32_bf16 v[72:87], v[52:55], v[112:119], v10
  v_exp_f32 v132, v132
  v_exp_f32 v133, v133
  v_exp_f32 v134, v134
  v_exp_f32 v135, v135
  s_waitcnt lgkmcnt(0)
  v_mfma_f32_32x32x16_bf16 v[88:103], v[24:27], v[4:7], 0
  v_exp_f32 v136, v136
  v_exp_f32 v137, v137
  ds_read_b128 v[32:35], v3 offset:17920
  ds_read_b32 v36, v2 offset:18944
  v_exp_f32 v138, v138
  v_exp_f32 v139, v139
  v_mfma_f32_32x32x8_bf16 v[88:103], v[28:29], v[8:9], v[88:103]
  v_exp_f32 v140, v140
  v_exp_f32 v141, v141
  s_mov_b64 exec, s[36:37]
  ds_read_b128 v[48:51], v1 offset:16640
  ds_read_b128 v[52:55], v1 offset:17280
  s_mov_b64 exec, -1
  v_exp_f32 v142, v142
  v_exp_f32 v143, v143
  v_smfmac_f32_32x32x32_bf16 v[56:71], v[40:43], v[120:127], v10
  v_exp_f32 v144, v144
  v_exp_f32 v145, v145
  v_exp_f32 v146, v146
  v_exp_f32 v147, v147
  v_smfmac_f32_32x32x32_bf16 v[56:71], v[44:47], v[128:135], v10
  v_exp_f32 v148, v148
  v_exp_f32 v149, v149
  v_exp_f32 v150, v150
  v_exp_f32 v151, v151
  v_mfma_f32_32x32x16_bf16 v[104:119], v[24:27], v[12:15], 0
  v_exp_f32 v88, v88
  v_exp_f32 v89, v89
  v_exp_f32 v90, v90
  v_exp_f32 v91, v91
  v_mfma_f32_32x32x8_bf16 v[104:119], v[28:29], v[16:17], v[104:119]
  v_exp_f32 v92, v92
  v_exp_f32 v93, v93
  v_exp_f32 v94, v94
  v_exp_f32 v95, v95
  v_smfmac_f32_32x32x32_bf16 v[72:87], v[40:43], v[136:143], v10
  v_exp_f32 v96, v96
  v_exp_f32 v97, v97
  v_exp_f32 v98, v98
  v_exp_f32 v99, v99
  v_smfmac_f32_32x32x32_bf16 v[72:87], v[44:47], v[144:151], v10
  v_exp_f32 v100, v100
  v_exp_f32 v101, v101
  v_exp_f32 v102, v102
  v_exp_f32 v103, v103
  s_waitcnt lgkmcnt(0)
  v_mfma_f32_32x32x16_bf16 v[120:135], v[32:35], v[4:7], 0
  v_exp_f32 v104, v104
  v_exp_f32 v105, v105
  ds_read_b128 v[24:27], v3 offset:20480
  ds_read_b32 v28, v2 offset:21504
  v_exp_f32 v106, v106
  v_exp_f32 v107, v107
  v_mfma_f32_32x32x8_bf16 v[120:135], v[36:37], v[8:9], v[120:135]
  v_exp_f32 v108, v108
  v_exp_f32 v109, v109
  s_mov_b64 exec, s[36:37]
  ds_read_b128 v[40:43], v1 offset:19200
  ds_read_b128 v[44:47], v1 offset:19840
  s_mov_b64 exec, -1
  v_exp_f32 v110, v110
  v_exp_f32 v111, v111
  v_smfmac_f32_32x32x32_bf16 v[56:71], v[48:51], v[88:95], v10
  v_exp_f32 v112, v112
  v_exp_f32 v113, v113
  v_exp_f32 v114, v114
  v_exp_f32 v115, v115
  v_smfmac_f32_32x32x32_bf16 v[56:71], v[52:55], v[96:103], v10
  v_exp_f32 v116, v116
  v_exp_f32 v117, v117
  v_exp_f32 v118, v118
  v_exp_f32 v119, v119
  v_mfma_f32_32x32x16_bf16 v[136:151], v[32:35], v[12:15], 0
  v_exp_f32 v120, v120
  v_exp_f32 v121, v121
  v_exp_f32 v122, v122
  v_exp_f32 v123, v123
  v_mfma_f32_32x32x8_bf16 v[136:151], v[36:37], v[16:17], v[136:151]
  v_exp_f32 v124, v124
  v_exp_f32 v125, v125
  v_exp_f32 v126, v126
  v_exp_f32 v127, v127
  v_smfmac_f32_32x32x32_bf16 v[72:87], v[48:51], v[104:111], v10
  v_exp_f32 v128, v128
  v_exp_f32 v129, v129
  v_exp_f32 v130, v130
  v_exp_f32 v131, v131
  v_smfmac_f32_32x32x32_bf16 v[72:87], v[52:55], v[112:119], v10
  v_exp_f32 v132, v132
  v_exp_f32 v133, v133
  v_exp_f32 v134, v134
  v_exp_f32 v135, v135
  s_waitcnt lgkmcnt(0)
  v_mfma_f32_32x32x16_bf16 v[88:103], v[24:27], v[4:7], 0
  v_exp_f32 v136, v136
  v_exp_f32 v137, v137
  ds_read_b128 v[32:35], v3 offset:23040
  ds_read_b32 v36, v2 offset:24064
  v_exp_f32 v138, v138
  v_exp_f32 v139, v139
  v_mfma_f32_32x32x8_bf16 v[88:103], v[28:29], v[8:9], v[88:103]
  v_exp_f32 v140, v140
  v_exp_f32 v141, v141
  s_mov_b64 exec, s[36:37]
  ds_read_b128 v[48:51], v1 offset:21760
  ds_read_b128 v[52:55], v1 offset:22400
  s_mov_b64 exec, -1
  v_exp_f32 v142, v142
  v_exp_f32 v143, v143
  v_smfmac_f32_32x32x32_bf16 v[56:71], v[40:43], v[120:127], v10
  v_exp_f32 v144, v144
  v_exp_f32 v145, v145
  v_exp_f32 v146, v146
  v_exp_f32 v147, v147
  v_smfmac_f32_32x32x32_bf16 v[56:71], v[44:47], v[128:135], v10
  v_exp_f32 v148, v148
  v_exp_f32 v149, v149
  v_exp_f32 v150, v150
  v_exp_f32 v151, v151
  v_add_u32 v3, 20480, v3
  v_add_u32 v2, 20480, v2
  v_add_u32 v1, 20480, v1
  s_bitcmp1_b32 s45, s44
  s_cbranch_scc1 L_EV
L_NEXT:
  s_sub_u32 s44, s44, 1
  s_cmp_lg_u32 s44, 0
  s_cbranch_scc1 L_LOOP
  v_smfmac_f32_32x32x32_bf16 v[72:87], v[40:43], v[136:143], v10
  v_smfmac_f32_32x32x32_bf16 v[72:87], v[44:47], v[144:151], v10
  s_setprio 3
  s_mov_b32 s46, 729808896
  s_mov_b32 s47, 1400897536
  s_mov_b32 s23, -2
  s_lshl_b32 s16, s4, 1
  s_add_u32 s16, s16, s3
  s_mul_i32 s21, s16, 163840
  s_mul_i32 s40, s6, 5120
  s_add_u32 s21, s21, s40
  s_add_u32 s21, s21, 344064
  s_add_u32 s22, s5, 0
  s_and_b32 s22, s22, 3
  s_mul_i32 s22, s22, 40960
  s_add_u32 s17, s21, s22
  s_add_u32 s8, s22, s40
  s_add_u32 s22, s5, 1
  s_and_b32 s22, s22, 3
  s_mul_i32 s22, s22, 40960
  s_add_u32 s18, s21, s22
  s_add_u32 s9, s22, s40
  s_add_u32 s22, s5, 2
  s_and_b32 s22, s22, 3
  s_mul_i32 s22, s22, 40960
  s_add_u32 s19, s21, s22
  s_add_u32 s10, s22, s40
  s_add_u32 s22, s5, 3
  s_and_b32 s22, s22, 3
  s_mul_i32 s22, s22, 40960
  s_add_u32 s20, s21, s22
  s_add_u32 s11, s22, s40
  s_waitcnt vmcnt(0) lgkmcnt(0)
  v_cndmask_b32 v22, v68, v64, s[38:39]
  v_cndmask_b32 v23, v84, v80, s[38:39]
  v_cmp_le_f32 s[48:49], s46, v22
  v_cmp_ge_f32 s[50:51], s47, v22
  v_cmp_le_f32 s[52:53], s46, v23
  v_cmp_ge_f32 s[54:55], s47, v23
  v_rcp_f32 v22, v22
  v_rcp_f32 v23, v23
  s_and_b64 s[48:49], s[48:49], s[50:51]
  s_and_b64 s[52:53], s[52:53], s[54:55]
  s_and_b64 s[48:49], s[48:49], s[52:53]
  s_cmp_eq_u64 s[48:49], -1
  s_cbranch_scc0 L_BAD
L_OK:
  v_mul_f32 v22, v22, v11
  v_mul_f32 v23, v23, v11
  v_mul_f32 v56, v56, v22
  v_mul_f32 v57, v57, v22
  v_mul_f32 v58, v58, v22
  v_mul_f32 v59, v59, v22
  v_mul_f32 v60, v60, v22
  v_mul_f32 v61, v61, v22
  v_mul_f32 v62, v62, v22
  v_mul_f32 v63, v63, v22
  v_mul_f32 v64, v64, v22
  v_mul_f32 v65, v65, v22
  v_mul_f32 v66, v66, v22
  v_mul_f32 v67, v67, v22
  v_cvt_pk_bf16_f32 v136, v56, v57
  v_cvt_pk_bf16_f32 v137, v58, v59
  v_cvt_pk_bf16_f32 v138, v60, v61
  v_cvt_pk_bf16_f32 v139, v62, v63
  v_cvt_pk_bf16_f32 v144, v64, v65
  v_cvt_pk_bf16_f32 v145, v66, v67
  v_min_u32 v136, s23, v136
  v_min_u32 v137, s23, v137
  v_min_u32 v138, s23, v138
  v_min_u32 v139, s23, v139
  buffer_store_dwordx4 v[136:139], v30, s[28:31], s26 offen offset:0 sc1
  v_mul_f32 v72, v72, v23
  v_mul_f32 v73, v73, v23
  v_mul_f32 v74, v74, v23
  v_mul_f32 v75, v75, v23
  v_mul_f32 v76, v76, v23
  v_mul_f32 v77, v77, v23
  v_mul_f32 v78, v78, v23
  v_mul_f32 v79, v79, v23
  v_mul_f32 v80, v80, v23
  v_mul_f32 v81, v81, v23
  v_mul_f32 v82, v82, v23
  v_mul_f32 v83, v83, v23
  v_cvt_pk_bf16_f32 v140, v72, v73
  v_cvt_pk_bf16_f32 v141, v74, v75
  v_cvt_pk_bf16_f32 v142, v76, v77
  v_cvt_pk_bf16_f32 v143, v78, v79
  v_cvt_pk_bf16_f32 v146, v80, v81
  v_cvt_pk_bf16_f32 v147, v82, v83
  v_min_u32 v140, s23, v140
  v_min_u32 v141, s23, v141
  v_min_u32 v142, s23, v142
  v_min_u32 v143, s23, v143
  buffer_store_dwordx4 v[140:143], v30, s[28:31], s26 offen offset:512 sc1
  v_min_u32 v144, s23, v144
  v_min_u32 v145, s23, v145
  v_min_u32 v146, s23, v146
  v_min_u32 v147, s23, v147
  s_mov_b32 exec_hi, 0
  buffer_store_dwordx4 v[144:147], v30, s[28:31], s26 offen offset:1024 sc1
  s_mov_b32 exec_hi, -1
  s_setprio 0
  s_cmp_eq_u32 s13, 0
  s_cbranch_scc1 L_NB
  s_barrier
L_NB:
  s_mov_b32 s72, s66
  s_mov_b32 s73, s67
  s_mov_b32 s74, 2621440
  s_mov_b32 s75, 0x00020000
  v_mov_b32 v2, s34
  v_mov_b32 v3, 0
  v_lshlrev_b32 v5, 4, v0
  v_add_u32 v6, 4096, v5
  v_and_b32 v13, 15, v0
  v_lshrrev_b32 v14, 4, v0
  v_bfe_u32 v12, v0, 1, 2
  v_xor_b32 v14, v14, v12
  v_lshl_add_u32 v14, v13, 2, v14
  v_lshlrev_b32 v14, 4, v14
  v_add_u32 v8, s8, v14
  v_add_u32 v9, s9, v14
  v_add_u32 v10, s10, v14
  v_add_u32 v11, s11, v14
  v_bfe_u32 v12, v0, 3, 2
  v_xor_b32 v12, v12, v0
  s_mul_i32 s22, s6, 40960
  v_lshl_add_u32 v12, v12, 4, s22
  s_lshl_b32 s22, s16, 6
  s_lshl_b32 s21, s6, 4
  s_add_u32 s22, s22, s21
  s_mul_i32 s22, s22, 1280
  s_mul_i32 s21, s5, 160
  s_add_u32 s22, s22, s21
  v_lshrrev_b32 v13, 2, v0
  v_mul_u32_u24 v13, 1280, v13
  v_and_b32 v14, 3, v0
  v_lshl_add_u32 v7, v14, 3, v13
  v_lshl_add_u32 v13, v14, 4, v13
  s_mov_b32 s60, 200000
  s_cmp_eq_u32 s13, 0
  s_cbranch_scc1 L_ELEAD
  s_waitcnt vmcnt(0)
  buffer_load_dwordx4 v[16:19], v5, s[28:31], s17 offen offset:0 sc1
  buffer_load_dwordx4 v[20:23], v5, s[28:31], s17 offen offset:1024 sc1
  buffer_load_dwordx4 v[24:27], v5, s[28:31], s17 offen offset:2048 sc1
  buffer_load_dwordx4 v[28:31], v5, s[28:31], s17 offen offset:3072 sc1
  buffer_load_dwordx4 v[32:35], v6, s[28:31], s17 offen offset:0 sc1
L_CHB0:
  s_waitcnt vmcnt(4)
  buffer_load_dwordx4 v[36:39], v5, s[28:31], s18 offen offset:0 sc1
  buffer_load_dwordx4 v[40:43], v5, s[28:31], s18 offen offset:1024 sc1
  buffer_load_dwordx4 v[44:47], v5, s[28:31], s18 offen offset:2048 sc1
  buffer_load_dwordx4 v[48:51], v5, s[28:31], s18 offen offset:3072 sc1
  buffer_load_dwordx4 v[52:55], v6, s[28:31], s18 offen offset:0 sc1
  v_mfma_f32_16x16x32_bf16 v[96:99], v[152:155], v[16:19], 0
  v_max3_u32 v15, v16, v17, v18
  v_mfma_f32_16x16x32_bf16 v[100:103], v[156:159], v[16:19], 0
  v_max_u32 v15, v19, v15
  v_mfma_f32_16x16x32_bf16 v[104:107], v[160:163], v[16:19], 0
  v_mfma_f32_16x16x32_bf16 v[108:111], v[164:167], v[16:19], 0
  v_mfma_f32_16x16x32_bf16 v[112:115], v[168:171], v[16:19], 0
  s_waitcnt vmcnt(8)
  v_mfma_f32_16x16x32_bf16 v[96:99], v[172:175], v[20:23], v[96:99]
  v_max3_u32 v15, v20, v21, v15
  v_mfma_f32_16x16x32_bf16 v[100:103], v[176:179], v[20:23], v[100:103]
  v_max3_u32 v15, v22, v23, v15
  v_mfma_f32_16x16x32_bf16 v[104:107], v[180:183], v[20:23], v[104:107]
  v_mfma_f32_16x16x32_bf16 v[108:111], v[184:187], v[20:23], v[108:111]
  v_mfma_f32_16x16x32_bf16 v[112:115], v[188:191], v[20:23], v[112:115]
  s_waitcnt vmcnt(7)
  v_mfma_f32_16x16x32_bf16 v[96:99], v[192:195], v[24:27], v[96:99]
  v_max3_u32 v15, v24, v25, v15
  v_mfma_f32_16x16x32_bf16 v[100:103], v[196:199], v[24:27], v[100:103]
  v_max3_u32 v15, v26, v27, v15
  v_mfma_f32_16x16x32_bf16 v[104:107], v[200:203], v[24:27], v[104:107]
  v_mfma_f32_16x16x32_bf16 v[108:111], v[204:207], v[24:27], v[108:111]
  v_mfma_f32_16x16x32_bf16 v[112:115], v[208:211], v[24:27], v[112:115]
  s_waitcnt vmcnt(6)
  v_mfma_f32_16x16x32_bf16 v[96:99], v[212:215], v[28:31], v[96:99]
  v_max3_u32 v15, v28, v29, v15
  v_mfma_f32_16x16x32_bf16 v[100:103], v[216:219], v[28:31], v[100:103]
  v_max3_u32 v15, v30, v31, v15
  v_mfma_f32_16x16x32_bf16 v[104:107], v[220:223], v[28:31], v[104:107]
  v_mfma_f32_16x16x32_bf16 v[108:111], v[224:227], v[28:31], v[108:111]
  v_mfma_f32_16x16x32_bf16 v[112:115], v[228:231], v[28:31], v[112:115]
  s_waitcnt vmcnt(5)
  v_mfma_f32_16x16x32_bf16 v[96:99], v[232:235], v[32:35], v[96:99]
  v_max3_u32 v15, v32, v33, v15
  v_mfma_f32_16x16x32_bf16 v[100:103], v[236:239], v[32:35], v[100:103]
  v_max3_u32 v15, v34, v35, v15
  v_mfma_f32_16x16x32_bf16 v[104:107], v[240:243], v[32:35], v[104:107]
  v_cmp_eq_u32 vcc, -1, v15
  v_mfma_f32_16x16x32_bf16 v[108:111], v[244:247], v[32:35], v[108:111]
  v_mfma_f32_16x16x32_bf16 v[112:115], v[248:251], v[32:35], v[112:115]
  s_cbranch_vccnz L_REB0
L_GOB0:
L_CHB1:
  s_waitcnt vmcnt(4)
  buffer_load_dwordx4 v[56:59], v5, s[28:31], s19 offen offset:0 sc1
  buffer_load_dwordx4 v[60:63], v5, s[28:31], s19 offen offset:1024 sc1
  buffer_load_dwordx4 v[64:67], v5, s[28:31], s19 offen offset:2048 sc1
  buffer_load_dwordx4 v[68:71], v5, s[28:31], s19 offen offset:3072 sc1
  buffer_load_dwordx4 v[72:75], v6, s[28:31], s19 offen offset:0 sc1
  v_mfma_f32_16x16x32_bf16 v[116:119], v[152:155], v[36:39], 0
  v_max3_u32 v15, v36, v37, v38
  v_mfma_f32_16x16x32_bf16 v[120:123], v[156:159], v[36:39], 0
  v_max_u32 v15, v39, v15
  v_mfma_f32_16x16x32_bf16 v[124:127], v[160:163], v[36:39], 0
  v_mfma_f32_16x16x32_bf16 v[128:131], v[164:167], v[36:39], 0
  v_mfma_f32_16x16x32_bf16 v[132:135], v[168:171], v[36:39], 0
  s_waitcnt vmcnt(8)
  v_mfma_f32_16x16x32_bf16 v[116:119], v[172:175], v[40:43], v[116:119]
  v_max3_u32 v15, v40, v41, v15
  v_mfma_f32_16x16x32_bf16 v[120:123], v[176:179], v[40:43], v[120:123]
  v_max3_u32 v15, v42, v43, v15
  v_mfma_f32_16x16x32_bf16 v[124:127], v[180:183], v[40:43], v[124:127]
  v_mfma_f32_16x16x32_bf16 v[128:131], v[184:187], v[40:43], v[128:131]
  ds_write_b128 v8, v[96:99] offset:0
  v_mfma_f32_16x16x32_bf16 v[132:135], v[188:191], v[40:43], v[132:135]
  s_waitcnt vmcnt(7)
  v_mfma_f32_16x16x32_bf16 v[116:119], v[192:195], v[44:47], v[116:119]
  v_max3_u32 v15, v44, v45, v15
  v_mfma_f32_16x16x32_bf16 v[120:123], v[196:199], v[44:47], v[120:123]
  v_max3_u32 v15, v46, v47, v15
  v_mfma_f32_16x16x32_bf16 v[124:127], v[200:203], v[44:47], v[124:127]
  v_mfma_f32_16x16x32_bf16 v[128:131], v[204:207], v[44:47], v[128:131]
  ds_write_b128 v8, v[100:103] offset:1024
  v_mfma_f32_16x16x32_bf16 v[132:135], v[208:211], v[44:47], v[132:135]
  s_waitcnt vmcnt(6)
  v_mfma_f32_16x16x32_bf16 v[116:119], v[212:215], v[48:51], v[116:119]
  v_max3_u32 v15, v48, v49, v15
  v_mfma_f32_16x16x32_bf16 v[120:123], v[216:219], v[48:51], v[120:123]
  v_max3_u32 v15, v50, v51, v15
  v_mfma_f32_16x16x32_bf16 v[124:127], v[220:223], v[48:51], v[124:127]
  v_mfma_f32_16x16x32_bf16 v[128:131], v[224:227], v[48:51], v[128:131]
  ds_write_b128 v8, v[104:107] offset:2048
  v_mfma_f32_16x16x32_bf16 v[132:135], v[228:231], v[48:51], v[132:135]
  s_waitcnt vmcnt(5)
  v_mfma_f32_16x16x32_bf16 v[116:119], v[232:235], v[52:55], v[116:119]
  v_max3_u32 v15, v52, v53, v15
  v_mfma_f32_16x16x32_bf16 v[120:123], v[236:239], v[52:55], v[120:123]
  v_max3_u32 v15, v54, v55, v15
  v_mfma_f32_16x16x32_bf16 v[124:127], v[240:243], v[52:55], v[124:127]
  v_cmp_eq_u32 vcc, -1, v15
  v_mfma_f32_16x16x32_bf16 v[128:131], v[244:247], v[52:55], v[128:131]
  ds_write_b128 v8, v[108:111] offset:3072
  v_mfma_f32_16x16x32_bf16 v[132:135], v[248:251], v[52:55], v[132:135]
  ds_write_b128 v8, v[112:115] offset:4096
  s_cbranch_vccnz L_REB1
L_GOB1:
  s_barrier
L_CHB2:
  s_waitcnt vmcnt(4)
  buffer_load_dwordx4 v[76:79], v5, s[28:31], s20 offen offset:0 sc1
  buffer_load_dwordx4 v[80:83], v5, s[28:31], s20 offen offset:1024 sc1
  buffer_load_dwordx4 v[84:87], v5, s[28:31], s20 offen offset:2048 sc1
  buffer_load_dwordx4 v[88:91], v5, s[28:31], s20 offen offset:3072 sc1
  buffer_load_dwordx4 v[92:95], v6, s[28:31], s20 offen offset:0 sc1
  v_mfma_f32_16x16x32_bf16 v[16:19], v[152:155], v[56:59], 0
  v_max3_u32 v15, v56, v57, v58
  v_mfma_f32_16x16x32_bf16 v[20:23], v[156:159], v[56:59], 0
  v_max_u32 v15, v59, v15
  v_mfma_f32_16x16x32_bf16 v[24:27], v[160:163], v[56:59], 0
  v_mfma_f32_16x16x32_bf16 v[28:31], v[164:167], v[56:59], 0
  v_mfma_f32_16x16x32_bf16 v[32:35], v[168:171], v[56:59], 0
  s_waitcnt vmcnt(8)
  v_mfma_f32_16x16x32_bf16 v[16:19], v[172:175], v[60:63], v[16:19]
  v_max3_u32 v15, v60, v61, v15
  v_mfma_f32_16x16x32_bf16 v[20:23], v[176:179], v[60:63], v[20:23]
  v_max3_u32 v15, v62, v63, v15
  v_mfma_f32_16x16x32_bf16 v[24:27], v[180:183], v[60:63], v[24:27]
  v_mfma_f32_16x16x32_bf16 v[28:31], v[184:187], v[60:63], v[28:31]
  ds_write_b128 v9, v[116:119] offset:0
  v_mfma_f32_16x16x32_bf16 v[32:35], v[188:191], v[60:63], v[32:35]
  s_waitcnt vmcnt(7)
  v_mfma_f32_16x16x32_bf16 v[16:19], v[192:195], v[64:67], v[16:19]
  v_max3_u32 v15, v64, v65, v15
  v_mfma_f32_16x16x32_bf16 v[20:23], v[196:199], v[64:67], v[20:23]
  v_max3_u32 v15, v66, v67, v15
  v_mfma_f32_16x16x32_bf16 v[24:27], v[200:203], v[64:67], v[24:27]
  v_mfma_f32_16x16x32_bf16 v[28:31], v[204:207], v[64:67], v[28:31]
  ds_write_b128 v9, v[120:123] offset:1024
  v_mfma_f32_16x16x32_bf16 v[32:35], v[208:211], v[64:67], v[32:35]
  s_waitcnt vmcnt(6)
  v_mfma_f32_16x16x32_bf16 v[16:19], v[212:215], v[68:71], v[16:19]
  v_max3_u32 v15, v68, v69, v15
  v_mfma_f32_16x16x32_bf16 v[20:23], v[216:219], v[68:71], v[20:23]
  v_max3_u32 v15, v70, v71, v15
  v_mfma_f32_16x16x32_bf16 v[24:27], v[220:223], v[68:71], v[24:27]
  v_mfma_f32_16x16x32_bf16 v[28:31], v[224:227], v[68:71], v[28:31]
  ds_write_b128 v9, v[124:127] offset:2048
  v_mfma_f32_16x16x32_bf16 v[32:35], v[228:231], v[68:71], v[32:35]
  s_waitcnt vmcnt(5)
  v_mfma_f32_16x16x32_bf16 v[16:19], v[232:235], v[72:75], v[16:19]
  v_max3_u32 v15, v72, v73, v15
  v_mfma_f32_16x16x32_bf16 v[20:23], v[236:239], v[72:75], v[20:23]
  v_max3_u32 v15, v74, v75, v15
  v_mfma_f32_16x16x32_bf16 v[24:27], v[240:243], v[72:75], v[24:27]
  v_cmp_eq_u32 vcc, -1, v15
  v_mfma_f32_16x16x32_bf16 v[28:31], v[244:247], v[72:75], v[28:31]
  ds_write_b128 v9, v[128:131] offset:3072
  v_mfma_f32_16x16x32_bf16 v[32:35], v[248:251], v[72:75], v[32:35]
  ds_write_b128 v9, v[132:135] offset:4096
  s_cbranch_vccnz L_REB2
L_GOB2:
L_CHB3:
  s_waitcnt vmcnt(4)
  v_mfma_f32_16x16x32_bf16 v[36:39], v[152:155], v[76:79], 0
  v_max3_u32 v15, v76, v77, v78
  v_mfma_f32_16x16x32_bf16 v[40:43], v[156:159], v[76:79], 0
  v_max_u32 v15, v79, v15
  v_mfma_f32_16x16x32_bf16 v[44:47], v[160:163], v[76:79], 0
  v_mfma_f32_16x16x32_bf16 v[48:51], v[164:167], v[76:79], 0
  v_mfma_f32_16x16x32_bf16 v[52:55], v[168:171], v[76:79], 0
  s_waitcnt vmcnt(3)
  v_mfma_f32_16x16x32_bf16 v[36:39], v[172:175], v[80:83], v[36:39]
  v_max3_u32 v15, v80, v81, v15
  v_mfma_f32_16x16x32_bf16 v[40:43], v[176:179], v[80:83], v[40:43]
  v_max3_u32 v15, v82, v83, v15
  v_mfma_f32_16x16x32_bf16 v[44:47], v[180:183], v[80:83], v[44:47]
  v_mfma_f32_16x16x32_bf16 v[48:51], v[184:187], v[80:83], v[48:51]
  ds_write_b128 v10, v[16:19] offset:0
  v_mfma_f32_16x16x32_bf16 v[52:55], v[188:191], v[80:83], v[52:55]
  s_waitcnt vmcnt(2)
  v_mfma_f32_16x16x32_bf16 v[36:39], v[192:195], v[84:87], v[36:39]
  v_max3_u32 v15, v84, v85, v15
  v_mfma_f32_16x16x32_bf16 v[40:43], v[196:199], v[84:87], v[40:43]
  v_max3_u32 v15, v86, v87, v15
  v_mfma_f32_16x16x32_bf16 v[44:47], v[200:203], v[84:87], v[44:47]
  v_mfma_f32_16x16x32_bf16 v[48:51], v[204:207], v[84:87], v[48:51]
  ds_write_b128 v10, v[20:23] offset:1024
  v_mfma_f32_16x16x32_bf16 v[52:55], v[208:211], v[84:87], v[52:55]
  s_waitcnt vmcnt(1)
  v_mfma_f32_16x16x32_bf16 v[36:39], v[212:215], v[88:91], v[36:39]
  v_max3_u32 v15, v88, v89, v15
  v_mfma_f32_16x16x32_bf16 v[40:43], v[216:219], v[88:91], v[40:43]
  v_max3_u32 v15, v90, v91, v15
  v_mfma_f32_16x16x32_bf16 v[44:47], v[220:223], v[88:91], v[44:47]
  v_mfma_f32_16x16x32_bf16 v[48:51], v[224:227], v[88:91], v[48:51]
  ds_write_b128 v10, v[24:27] offset:2048
  v_mfma_f32_16x16x32_bf16 v[52:55], v[228:231], v[88:91], v[52:55]
  s_waitcnt vmcnt(0)
  v_mfma_f32_16x16x32_bf16 v[36:39], v[232:235], v[92:95], v[36:39]
  v_max3_u32 v15, v92, v93, v15
  v_mfma_f32_16x16x32_bf16 v[40:43], v[236:239], v[92:95], v[40:43]
  v_max3_u32 v15, v94, v95, v15
  v_mfma_f32_16x16x32_bf16 v[44:47], v[240:243], v[92:95], v[44:47]
  v_cmp_eq_u32 vcc, -1, v15
  v_mfma_f32_16x16x32_bf16 v[48:51], v[244:247], v[92:95], v[48:51]
  ds_write_b128 v10, v[28:31] offset:3072
  v_mfma_f32_16x16x32_bf16 v[52:55], v[248:251], v[92:95], v[52:55]
  ds_write_b128 v10, v[32:35] offset:4096
  s_cbranch_vccnz L_REB3
L_GOB3:
  s_waitcnt lgkmcnt(5)
  s_nop 6
  ds_write_b128 v11, v[36:39] offset:0
  ds_write_b128 v11, v[40:43] offset:1024
  ds_write_b128 v11, v[44:47] offset:2048
  ds_write_b128 v11, v[48:51] offset:3072
  ds_write_b128 v11, v[52:55] offset:4096
  s_waitcnt lgkmcnt(0)
  s_barrier
  s_branch L_FIN
L_ELEAD:
  s_waitcnt vmcnt(0)
  buffer_load_dwordx4 v[16:19], v5, s[28:31], s17 offen offset:0 sc1
  buffer_load_dwordx4 v[20:23], v5, s[28:31], s17 offen offset:1024 sc1
  buffer_load_dwordx4 v[24:27], v5, s[28:31], s17 offen offset:2048 sc1
  buffer_load_dwordx4 v[28:31], v5, s[28:31], s17 offen offset:3072 sc1
  buffer_load_dwordx4 v[32:35], v6, s[28:31], s17 offen offset:0 sc1
  buffer_load_dwordx4 v[36:39], v5, s[28:31], s18 offen offset:0 sc1
  buffer_load_dwordx4 v[40:43], v5, s[28:31], s18 offen offset:1024 sc1
  buffer_load_dwordx4 v[44:47], v5, s[28:31], s18 offen offset:2048 sc1
  buffer_load_dwordx4 v[48:51], v5, s[28:31], s18 offen offset:3072 sc1
  buffer_load_dwordx4 v[52:55], v6, s[28:31], s18 offen offset:0 sc1
  buffer_load_dwordx4 v[56:59], v5, s[28:31], s19 offen offset:0 sc1
  buffer_load_dwordx4 v[60:63], v5, s[28:31], s19 offen offset:1024 sc1
  buffer_load_dwordx4 v[64:67], v5, s[28:31], s19 offen offset:2048 sc1
  buffer_load_dwordx4 v[68:71], v5, s[28:31], s19 offen offset:3072 sc1
  buffer_load_dwordx4 v[72:75], v6, s[28:31], s19 offen offset:0 sc1
  buffer_load_dwordx4 v[76:79], v5, s[28:31], s20 offen offset:0 sc1
  buffer_load_dwordx4 v[80:83], v5, s[28:31], s20 offen offset:1024 sc1
  buffer_load_dwordx4 v[84:87], v5, s[28:31], s20 offen offset:2048 sc1
  buffer_load_dwordx4 v[88:91], v5, s[28:31], s20 offen offset:3072 sc1
  buffer_load_dwordx4 v[92:95], v6, s[28:31], s20 offen offset:0 sc1
L_CHA0:
  s_waitcnt vmcnt(19)
  v_mfma_f32_16x16x32_bf16 v[96:99], v[152:155], v[16:19], 0
  v_max3_u32 v15, v16, v17, v18
  v_mfma_f32_16x16x32_bf16 v[100:103], v[156:159], v[16:19], 0
  v_max_u32 v15, v19, v15
  v_mfma_f32_16x16x32_bf16 v[104:107], v[160:163], v[16:19], 0
  v_mfma_f32_16x16x32_bf16 v[108:111], v[164:167], v[16:19], 0
  v_mfma_f32_16x16x32_bf16 v[112:115], v[168:171], v[16:19], 0
  s_waitcnt vmcnt(18)
  v_mfma_f32_16x16x32_bf16 v[96:99], v[172:175], v[20:23], v[96:99]
  v_max3_u32 v15, v20, v21, v15
  v_mfma_f32_16x16x32_bf16 v[100:103], v[176:179], v[20:23], v[100:103]
  v_max3_u32 v15, v22, v23, v15
  v_mfma_f32_16x16x32_bf16 v[104:107], v[180:183], v[20:23], v[104:107]
  v_mfma_f32_16x16x32_bf16 v[108:111], v[184:187], v[20:23], v[108:111]
  v_mfma_f32_16x16x32_bf16 v[112:115], v[188:191], v[20:23], v[112:115]
  s_waitcnt vmcnt(17)
  v_mfma_f32_16x16x32_bf16 v[96:99], v[192:195], v[24:27], v[96:99]
  v_max3_u32 v15, v24, v25, v15
  v_mfma_f32_16x16x32_bf16 v[100:103], v[196:199], v[24:27], v[100:103]
  v_max3_u32 v15, v26, v27, v15
  v_mfma_f32_16x16x32_bf16 v[104:107], v[200:203], v[24:27], v[104:107]
  v_mfma_f32_16x16x32_bf16 v[108:111], v[204:207], v[24:27], v[108:111]
  v_mfma_f32_16x16x32_bf16 v[112:115], v[208:211], v[24:27], v[112:115]
  s_waitcnt vmcnt(16)
  v_mfma_f32_16x16x32_bf16 v[96:99], v[212:215], v[28:31], v[96:99]
  v_max3_u32 v15, v28, v29, v15
  v_mfma_f32_16x16x32_bf16 v[100:103], v[216:219], v[28:31], v[100:103]
  v_max3_u32 v15, v30, v31, v15
  v_mfma_f32_16x16x32_bf16 v[104:107], v[220:223], v[28:31], v[104:107]
  v_mfma_f32_16x16x32_bf16 v[108:111], v[224:227], v[28:31], v[108:111]
  v_mfma_f32_16x16x32_bf16 v[112:115], v[228:231], v[28:31], v[112:115]
  s_waitcnt vmcnt(15)
  v_mfma_f32_16x16x32_bf16 v[96:99], v[232:235], v[32:35], v[96:99]
  v_max3_u32 v15, v32, v33, v15
  v_mfma_f32_16x16x32_bf16 v[100:103], v[236:239], v[32:35], v[100:103]
  v_max3_u32 v15, v34, v35, v15
  v_mfma_f32_16x16x32_bf16 v[104:107], v[240:243], v[32:35], v[104:107]
  v_cmp_eq_u32 vcc, -1, v15
  v_mfma_f32_16x16x32_bf16 v[108:111], v[244:247], v[32:35], v[108:111]
  v_mfma_f32_16x16x32_bf16 v[112:115], v[248:251], v[32:35], v[112:115]
  s_cbranch_vccnz L_REA0
L_GOA0:
  s_barrier
L_CHA1:
  s_waitcnt vmcnt(14)
  v_mfma_f32_16x16x32_bf16 v[116:119], v[152:155], v[36:39], 0
  v_max3_u32 v15, v36, v37, v38
  v_mfma_f32_16x16x32_bf16 v[120:123], v[156:159], v[36:39], 0
  v_max_u32 v15, v39, v15
  v_mfma_f32_16x16x32_bf16 v[124:127], v[160:163], v[36:39], 0
  v_mfma_f32_16x16x32_bf16 v[128:131], v[164:167], v[36:39], 0
  v_mfma_f32_16x16x32_bf16 v[132:135], v[168:171], v[36:39], 0
  s_waitcnt vmcnt(13)
  v_mfma_f32_16x16x32_bf16 v[116:119], v[172:175], v[40:43], v[116:119]
  v_max3_u32 v15, v40, v41, v15
  v_mfma_f32_16x16x32_bf16 v[120:123], v[176:179], v[40:43], v[120:123]
  v_max3_u32 v15, v42, v43, v15
  v_mfma_f32_16x16x32_bf16 v[124:127], v[180:183], v[40:43], v[124:127]
  v_mfma_f32_16x16x32_bf16 v[128:131], v[184:187], v[40:43], v[128:131]
  ds_write_b128 v8, v[96:99] offset:0
  v_mfma_f32_16x16x32_bf16 v[132:135], v[188:191], v[40:43], v[132:135]
  s_waitcnt vmcnt(12)
  v_mfma_f32_16x16x32_bf16 v[116:119], v[192:195], v[44:47], v[116:119]
  v_max3_u32 v15, v44, v45, v15
  v_mfma_f32_16x16x32_bf16 v[120:123], v[196:199], v[44:47], v[120:123]
  v_max3_u32 v15, v46, v47, v15
  v_mfma_f32_16x16x32_bf16 v[124:127], v[200:203], v[44:47], v[124:127]
  v_mfma_f32_16x16x32_bf16 v[128:131], v[204:207], v[44:47], v[128:131]
  ds_write_b128 v8, v[100:103] offset:1024
  v_mfma_f32_16x16x32_bf16 v[132:135], v[208:211], v[44:47], v[132:135]
  s_waitcnt vmcnt(11)
  v_mfma_f32_16x16x32_bf16 v[116:119], v[212:215], v[48:51], v[116:119]
  v_max3_u32 v15, v48, v49, v15
  v_mfma_f32_16x16x32_bf16 v[120:123], v[216:219], v[48:51], v[120:123]
  v_max3_u32 v15, v50, v51, v15
  v_mfma_f32_16x16x32_bf16 v[124:127], v[220:223], v[48:51], v[124:127]
  v_mfma_f32_16x16x32_bf16 v[128:131], v[224:227], v[48:51], v[128:131]
  ds_write_b128 v8, v[104:107] offset:2048
  v_mfma_f32_16x16x32_bf16 v[132:135], v[228:231], v[48:51], v[132:135]
  s_waitcnt vmcnt(10)
  v_mfma_f32_16x16x32_bf16 v[116:119], v[232:235], v[52:55], v[116:119]
  v_max3_u32 v15, v52, v53, v15
  v_mfma_f32_16x16x32_bf16 v[120:123], v[236:239], v[52:55], v[120:123]
  v_max3_u32 v15, v54, v55, v15
  v_mfma_f32_16x16x32_bf16 v[124:127], v[240:243], v[52:55], v[124:127]
  v_cmp_eq_u32 vcc, -1, v15
  v_mfma_f32_16x16x32_bf16 v[128:131], v[244:247], v[52:55], v[128:131]
  ds_write_b128 v8, v[108:111] offset:3072
  v_mfma_f32_16x16x32_bf16 v[132:135], v[248:251], v[52:55], v[132:135]
  ds_write_b128 v8, v[112:115] offset:4096
  s_cbranch_vccnz L_REA1
L_GOA1:
L_CHA2:
  s_waitcnt vmcnt(9)
  v_mfma_f32_16x16x32_bf16 v[16:19], v[152:155], v[56:59], 0
  v_max3_u32 v15, v56, v57, v58
  v_mfma_f32_16x16x32_bf16 v[20:23], v[156:159], v[56:59], 0
  v_max_u32 v15, v59, v15
  v_mfma_f32_16x16x32_bf16 v[24:27], v[160:163], v[56:59], 0
  v_mfma_f32_16x16x32_bf16 v[28:31], v[164:167], v[56:59], 0
  v_mfma_f32_16x16x32_bf16 v[32:35], v[168:171], v[56:59], 0
  s_waitcnt vmcnt(8)
  v_mfma_f32_16x16x32_bf16 v[16:19], v[172:175], v[60:63], v[16:19]
  v_max3_u32 v15, v60, v61, v15
  v_mfma_f32_16x16x32_bf16 v[20:23], v[176:179], v[60:63], v[20:23]
  v_max3_u32 v15, v62, v63, v15
  v_mfma_f32_16x16x32_bf16 v[24:27], v[180:183], v[60:63], v[24:27]
  v_mfma_f32_16x16x32_bf16 v[28:31], v[184:187], v[60:63], v[28:31]
  ds_write_b128 v9, v[116:119] offset:0
  v_mfma_f32_16x16x32_bf16 v[32:35], v[188:191], v[60:63], v[32:35]
  s_waitcnt vmcnt(7)
  v_mfma_f32_16x16x32_bf16 v[16:19], v[192:195], v[64:67], v[16:19]
  v_max3_u32 v15, v64, v65, v15
  v_mfma_f32_16x16x32_bf16 v[20:23], v[196:199], v[64:67], v[20:23]
  v_max3_u32 v15, v66, v67, v15
  v_mfma_f32_16x16x32_bf16 v[24:27], v[200:203], v[64:67], v[24:27]
  v_mfma_f32_16x16x32_bf16 v[28:31], v[204:207], v[64:67], v[28:31]
  ds_write_b128 v9, v[120:123] offset:1024
  v_mfma_f32_16x16x32_bf16 v[32:35], v[208:211], v[64:67], v[32:35]
  s_waitcnt vmcnt(6)
  v_mfma_f32_16x16x32_bf16 v[16:19], v[212:215], v[68:71], v[16:19]
  v_max3_u32 v15, v68, v69, v15
  v_mfma_f32_16x16x32_bf16 v[20:23], v[216:219], v[68:71], v[20:23]
  v_max3_u32 v15, v70, v71, v15
  v_mfma_f32_16x16x32_bf16 v[24:27], v[220:223], v[68:71], v[24:27]
  v_mfma_f32_16x16x32_bf16 v[28:31], v[224:227], v[68:71], v[28:31]
  ds_write_b128 v9, v[124:127] offset:2048
  v_mfma_f32_16x16x32_bf16 v[32:35], v[228:231], v[68:71], v[32:35]
  s_waitcnt vmcnt(5)
  v_mfma_f32_16x16x32_bf16 v[16:19], v[232:235], v[72:75], v[16:19]
  v_max3_u32 v15, v72, v73, v15
  v_mfma_f32_16x16x32_bf16 v[20:23], v[236:239], v[72:75], v[20:23]
  v_max3_u32 v15, v74, v75, v15
  v_mfma_f32_16x16x32_bf16 v[24:27], v[240:243], v[72:75], v[24:27]
  v_cmp_eq_u32 vcc, -1, v15
  v_mfma_f32_16x16x32_bf16 v[28:31], v[244:247], v[72:75], v[28:31]
  ds_write_b128 v9, v[128:131] offset:3072
  v_mfma_f32_16x16x32_bf16 v[32:35], v[248:251], v[72:75], v[32:35]
  ds_write_b128 v9, v[132:135] offset:4096
  s_cbranch_vccnz L_REA2
L_GOA2:
L_CHA3:
  s_waitcnt vmcnt(4)
  v_mfma_f32_16x16x32_bf16 v[36:39], v[152:155], v[76:79], 0
  v_max3_u32 v15, v76, v77, v78
  v_mfma_f32_16x16x32_bf16 v[40:43], v[156:159], v[76:79], 0
  v_max_u32 v15, v79, v15
  v_mfma_f32_16x16x32_bf16 v[44:47], v[160:163], v[76:79], 0
  v_mfma_f32_16x16x32_bf16 v[48:51], v[164:167], v[76:79], 0
  v_mfma_f32_16x16x32_bf16 v[52:55], v[168:171], v[76:79], 0
  s_waitcnt vmcnt(3)
  v_mfma_f32_16x16x32_bf16 v[36:39], v[172:175], v[80:83], v[36:39]
  v_max3_u32 v15, v80, v81, v15
  v_mfma_f32_16x16x32_bf16 v[40:43], v[176:179], v[80:83], v[40:43]
  v_max3_u32 v15, v82, v83, v15
  v_mfma_f32_16x16x32_bf16 v[44:47], v[180:183], v[80:83], v[44:47]
  v_mfma_f32_16x16x32_bf16 v[48:51], v[184:187], v[80:83], v[48:51]
  ds_write_b128 v10, v[16:19] offset:0
  v_mfma_f32_16x16x32_bf16 v[52:55], v[188:191], v[80:83], v[52:55]
  s_waitcnt vmcnt(2)
  v_mfma_f32_16x16x32_bf16 v[36:39], v[192:195], v[84:87], v[36:39]
  v_max3_u32 v15, v84, v85, v15
  v_mfma_f32_16x16x32_bf16 v[40:43], v[196:199], v[84:87], v[40:43]
  v_max3_u32 v15, v86, v87, v15
  v_mfma_f32_16x16x32_bf16 v[44:47], v[200:203], v[84:87], v[44:47]
  v_mfma_f32_16x16x32_bf16 v[48:51], v[204:207], v[84:87], v[48:51]
  ds_write_b128 v10, v[20:23] offset:1024
  v_mfma_f32_16x16x32_bf16 v[52:55], v[208:211], v[84:87], v[52:55]
  s_waitcnt vmcnt(1)
  v_mfma_f32_16x16x32_bf16 v[36:39], v[212:215], v[88:91], v[36:39]
  v_max3_u32 v15, v88, v89, v15
  v_mfma_f32_16x16x32_bf16 v[40:43], v[216:219], v[88:91], v[40:43]
  v_max3_u32 v15, v90, v91, v15
  v_mfma_f32_16x16x32_bf16 v[44:47], v[220:223], v[88:91], v[44:47]
  v_mfma_f32_16x16x32_bf16 v[48:51], v[224:227], v[88:91], v[48:51]
  ds_write_b128 v10, v[24:27] offset:2048
  v_mfma_f32_16x16x32_bf16 v[52:55], v[228:231], v[88:91], v[52:55]
  s_waitcnt vmcnt(0)
  v_mfma_f32_16x16x32_bf16 v[36:39], v[232:235], v[92:95], v[36:39]
  v_max3_u32 v15, v92, v93, v15
  v_mfma_f32_16x16x32_bf16 v[40:43], v[236:239], v[92:95], v[40:43]
  v_max3_u32 v15, v94, v95, v15
  v_mfma_f32_16x16x32_bf16 v[44:47], v[240:243], v[92:95], v[44:47]
  v_cmp_eq_u32 vcc, -1, v15
  v_mfma_f32_16x16x32_bf16 v[48:51], v[244:247], v[92:95], v[48:51]
  ds_write_b128 v10, v[28:31] offset:3072
  v_mfma_f32_16x16x32_bf16 v[52:55], v[248:251], v[92:95], v[52:55]
  ds_write_b128 v10, v[32:35] offset:4096
  s_cbranch_vccnz L_REA3
L_GOA3:
  s_waitcnt lgkmcnt(5)
  s_nop 6
  ds_write_b128 v11, v[36:39] offset:0
  ds_write_b128 v11, v[40:43] offset:1024
  ds_write_b128 v11, v[44:47] offset:2048
  ds_write_b128 v11, v[48:51] offset:3072
  ds_write_b128 v11, v[52:55] offset:4096
  s_waitcnt lgkmcnt(0)
  s_barrier
  ds_read_b128 v[56:59], v12 offset:0
  ds_read_b128 v[60:63], v12 offset:1024
  ds_read_b128 v[64:67], v12 offset:2048
  ds_read_b128 v[68:71], v12 offset:3072
  ds_read_b128 v[72:75], v12 offset:4096
  ds_read_b128 v[76:79], v12 offset:5120
  ds_read_b128 v[80:83], v12 offset:6144
  ds_read_b128 v[84:87], v12 offset:7168
  ds_read_b128 v[88:91], v12 offset:8192
  ds_read_b128 v[92:95], v12 offset:9216
  s_waitcnt lgkmcnt(4)
  ds_read_b128 v[96:99], v12 offset:10240
  ds_read_b128 v[100:103], v12 offset:11264
  ds_read_b128 v[104:107], v12 offset:12288
  ds_read_b128 v[108:111], v12 offset:13312
  ds_read_b128 v[112:115], v12 offset:14336
  ds_read_b128 v[116:119], v12 offset:15360
  ds_read_b128 v[120:123], v12 offset:16384
  ds_read_b128 v[124:127], v12 offset:17408
  ds_read_b128 v[128:131], v12 offset:18432
  ds_read_b128 v[132:135], v12 offset:19456
  s_waitcnt lgkmcnt(10)
  v_add_f32 v56, v56, v76
  v_add_f32 v57, v57, v77
  v_add_f32 v58, v58, v78
  v_add_f32 v59, v59, v79
  v_add_f32 v60, v60, v80
  v_add_f32 v61, v61, v81
  v_add_f32 v62, v62, v82
  v_add_f32 v63, v63, v83
  v_add_f32 v64, v64, v84
  v_add_f32 v65, v65, v85
  v_add_f32 v66, v66, v86
  v_add_f32 v67, v67, v87
  v_add_f32 v68, v68, v88
  v_add_f32 v69, v69, v89
  v_add_f32 v70, v70, v90
  v_add_f32 v71, v71, v91
  v_add_f32 v72, v72, v92
  v_add_f32 v73, v73, v93
  v_add_f32 v74, v74, v94
  v_add_f32 v75, v75, v95
  s_waitcnt lgkmcnt(0)
  v_add_f32 v96, v96, v116
  v_add_f32 v97, v97, v117
  v_add_f32 v98, v98, v118
  v_add_f32 v99, v99, v119
  v_add_f32 v100, v100, v120
  v_add_f32 v101, v101, v121
  v_add_f32 v102, v102, v122
  v_add_f32 v103, v103, v123
  v_add_f32 v104, v104, v124
  v_add_f32 v105, v105, v125
  v_add_f32 v106, v106, v126
  v_add_f32 v107, v107, v127
  v_add_f32 v108, v108, v128
  v_add_f32 v109, v109, v129
  v_add_f32 v110, v110, v130
  v_add_f32 v111, v111, v131
  v_add_f32 v112, v112, v132
  v_add_f32 v113, v113, v133
  v_add_f32 v114, v114, v134
  v_add_f32 v115, v115, v135
  v_add_f32 v16, v56, v96
  v_add_f32 v17, v57, v97
  v_add_f32 v18, v58, v98
  v_add_f32 v19, v59, v99
  v_add_f32 v20, v60, v100
  v_add_f32 v21, v61, v101
  v_add_f32 v22, v62, v102
  v_add_f32 v23, v63, v103
  v_add_f32 v24, v64, v104
  v_add_f32 v25, v65, v105
  v_add_f32 v26, v66, v106
  v_add_f32 v27, v67, v107
  v_add_f32 v28, v68, v108
  v_add_f32 v29, v69, v109
  v_add_f32 v30, v70, v110
  v_add_f32 v31, v71, v111
  v_add_f32 v32, v72, v112
  v_add_f32 v33, v73, v113
  v_add_f32 v34, v74, v114
  v_add_f32 v35, v75, v115
  s_barrier
  ds_read_b128 v[56:59], v12 offset:20480
  ds_read_b128 v[60:63], v12 offset:21504
  ds_read_b128 v[64:67], v12 offset:22528
  ds_read_b128 v[68:71], v12 offset:23552
  ds_read_b128 v[72:75], v12 offset:24576
  ds_read_b128 v[76:79], v12 offset:25600
  ds_read_b128 v[80:83], v12 offset:26624
  ds_read_b128 v[84:87], v12 offset:27648
  ds_read_b128 v[88:91], v12 offset:28672
  ds_read_b128 v[92:95], v12 offset:29696
  s_waitcnt lgkmcnt(4)
  ds_read_b128 v[96:99], v12 offset:30720
  ds_read_b128 v[100:103], v12 offset:31744
  ds_read_b128 v[104:107], v12 offset:32768
  ds_read_b128 v[108:111], v12 offset:33792
  ds_read_b128 v[112:115], v12 offset:34816
  ds_read_b128 v[116:119], v12 offset:35840
  ds_read_b128 v[120:123], v12 offset:36864
  ds_read_b128 v[124:127], v12 offset:37888
  ds_read_b128 v[128:131], v12 offset:38912
  ds_read_b128 v[132:135], v12 offset:39936
  s_waitcnt lgkmcnt(10)
  v_add_f32 v56, v56, v76
  v_add_f32 v57, v57, v77
  v_add_f32 v58, v58, v78
  v_add_f32 v59, v59, v79
  v_add_f32 v60, v60, v80
  v_add_f32 v61, v61, v81
  v_add_f32 v62, v62, v82
  v_add_f32 v63, v63, v83
  v_add_f32 v64, v64, v84
  v_add_f32 v65, v65, v85
  v_add_f32 v66, v66, v86
  v_add_f32 v67, v67, v87
  v_add_f32 v68, v68, v88
  v_add_f32 v69, v69, v89
  v_add_f32 v70, v70, v90
  v_add_f32 v71, v71, v91
  v_add_f32 v72, v72, v92
  v_add_f32 v73, v73, v93
  v_add_f32 v74, v74, v94
  v_add_f32 v75, v75, v95
  v_add_f32 v56, v56, v16
  v_add_f32 v57, v57, v17
  v_add_f32 v58, v58, v18
  v_add_f32 v59, v59, v19
  v_add_f32 v60, v60, v20
  v_add_f32 v61, v61, v21
  v_add_f32 v62, v62, v22
  v_add_f32 v63, v63, v23
  v_add_f32 v64, v64, v24
  v_add_f32 v65, v65, v25
  v_add_f32 v66, v66, v26
  v_add_f32 v67, v67, v27
  v_add_f32 v68, v68, v28
  v_add_f32 v69, v69, v29
  v_add_f32 v70, v70, v30
  v_add_f32 v71, v71, v31
  v_add_f32 v72, v72, v32
  v_add_f32 v73, v73, v33
  v_add_f32 v74, v74, v34
  v_add_f32 v75, v75, v35
  s_waitcnt lgkmcnt(0)
  v_add_f32 v96, v96, v116
  v_add_f32 v97, v97, v117
  v_add_f32 v98, v98, v118
  v_add_f32 v99, v99, v119
  v_add_f32 v100, v100, v120
  v_add_f32 v101, v101, v121
  v_add_f32 v102, v102, v122
  v_add_f32 v103, v103, v123
  v_add_f32 v104, v104, v124
  v_add_f32 v105, v105, v125
  v_add_f32 v106, v106, v126
  v_add_f32 v107, v107, v127
  v_add_f32 v108, v108, v128
  v_add_f32 v109, v109, v129
  v_add_f32 v110, v110, v130
  v_add_f32 v111, v111, v131
  v_add_f32 v112, v112, v132
  v_add_f32 v113, v113, v133
  v_add_f32 v114, v114, v134
  v_add_f32 v115, v115, v135
  v_add_f32 v16, v56, v96
  v_add_f32 v17, v57, v97
  v_add_f32 v18, v58, v98
  v_add_f32 v19, v59, v99
  v_add_f32 v20, v60, v100
  v_add_f32 v21, v61, v101
  v_add_f32 v22, v62, v102
  v_add_f32 v23, v63, v103
  v_add_f32 v24, v64, v104
  v_add_f32 v25, v65, v105
  v_add_f32 v26, v66, v106
  v_add_f32 v27, v67, v107
  v_add_f32 v28, v68, v108
  v_add_f32 v29, v69, v109
  v_add_f32 v30, v70, v110
  v_add_f32 v31, v71, v111
  v_add_f32 v32, v72, v112
  v_add_f32 v33, v73, v113
  v_add_f32 v34, v74, v114
  v_add_f32 v35, v75, v115
  v_cvt_pk_bf16_f32 v40, v16, v17
  v_cvt_pk_bf16_f32 v41, v18, v19
  v_cvt_pk_bf16_f32 v42, v20, v21
  v_cvt_pk_bf16_f32 v43, v22, v23
  v_cvt_pk_bf16_f32 v44, v24, v25
  v_cvt_pk_bf16_f32 v45, v26, v27
  v_cvt_pk_bf16_f32 v46, v28, v29
  v_cvt_pk_bf16_f32 v47, v30, v31
  v_cvt_pk_bf16_f32 v48, v32, v33
  v_cvt_pk_bf16_f32 v49, v34, v35
  buffer_store_dwordx4 v[40:43], v13, s[72:75], s22 offen
  buffer_store_dwordx4 v[44:47], v13, s[72:75], s22 offen offset:64
  buffer_store_dwordx2 v[48:49], v7, s[72:75], s22 offen offset:128
  s_or_b32 s21, s2, s6
  s_cmp_eq_u32 s21, 0
  s_cbranch_scc0 L_FIN
  s_mov_b32 s21, 7225344
  s_mov_b64 exec, 1
  buffer_store_dword v2, v3, s[28:31], s21 offen sc1
L_FIN:
L_FIN2:
  s_endpgm
L_EV:
  s_cmp_eq_u32 s44, 8
  s_cbranch_scc0 L_E0
  s_cmp_eq_u32 s13, 0
  s_cbranch_scc0 L_RL2
  s_barrier
  s_branch L_NEXT
L_RL2:
  s_cmp_eq_u32 s6, 5
  s_cbranch_scc0 L_NEXT
  s_waitcnt vmcnt(0)
  s_mov_b32 s56, 0x05040100
  s_mov_b32 s57, 0x07060302
  s_mov_b32 exec_hi, 0x3ffff
  v_perm_b32 v184, v156, v152, s56
  v_perm_b32 v185, v164, v160, s56
  v_perm_b32 v186, v172, v168, s56
  v_perm_b32 v187, v180, v176, s56
  buffer_store_dwordx4 v[184:187], v218, s[28:31], s35 offen offset:0 sc1
  v_perm_b32 v188, v156, v152, s57
  v_perm_b32 v189, v164, v160, s57
  v_perm_b32 v190, v172, v168, s57
  v_perm_b32 v191, v180, v176, s57
  buffer_store_dwordx4 v[188:191], v218, s[28:31], s35 offen offset:16 sc1
  v_perm_b32 v192, v157, v153, s56
  v_perm_b32 v193, v165, v161, s56
  v_perm_b32 v194, v173, v169, s56
  v_perm_b32 v195, v181, v177, s56
  buffer_store_dwordx4 v[192:195], v218, s[28:31], s35 offen offset:32 sc1
  v_perm_b32 v196, v157, v153, s57
  v_perm_b32 v197, v165, v161, s57
  v_perm_b32 v198, v173, v169, s57
  v_perm_b32 v199, v181, v177, s57
  buffer_store_dwordx4 v[196:199], v218, s[28:31], s35 offen offset:48 sc1
  v_perm_b32 v200, v158, v154, s56
  v_perm_b32 v201, v166, v162, s56
  v_perm_b32 v202, v174, v170, s56
  v_perm_b32 v203, v182, v178, s56
  buffer_store_dwordx4 v[200:203], v219, s[28:31], s35 offen offset:0 sc1
  v_perm_b32 v204, v158, v154, s57
  v_perm_b32 v205, v166, v162, s57
  v_perm_b32 v206, v174, v170, s57
  v_perm_b32 v207, v182, v178, s57
  buffer_store_dwordx4 v[204:207], v219, s[28:31], s35 offen offset:16 sc1
  v_perm_b32 v208, v159, v155, s56
  v_perm_b32 v209, v167, v163, s56
  v_perm_b32 v210, v175, v171, s56
  v_perm_b32 v211, v183, v179, s56
  buffer_store_dwordx4 v[208:211], v219, s[28:31], s35 offen offset:32 sc1
  v_perm_b32 v212, v159, v155, s57
  v_perm_b32 v213, v167, v163, s57
  v_perm_b32 v214, v175, v171, s57
  v_perm_b32 v215, v183, v179, s57
  buffer_store_dwordx4 v[212:215], v219, s[28:31], s35 offen offset:48 sc1
  s_mov_b32 exec_hi, -1
  s_branch L_NEXT
L_E0:
  s_cmp_eq_u32 s44, 6
  s_cbranch_scc0 L_E1
  s_lshl_b32 s56, s2, 2
  s_add_u32 s56, s56, s6
  s_lshl_b32 s56, s56, 2
  s_add_u32 s56, s56, 7233776
  v_mov_b32 v21, 0
  s_waitcnt vmcnt(0)
  v_mov_b32 v20, s34
  s_mov_b64 exec, 1
  buffer_store_dword v20, v21, s[28:31], s56 offen sc1
  s_mov_b64 exec, -1
  s_branch L_NEXT
L_E1:
  s_sub_u32 s56, s44, s13
  s_cmp_eq_u32 s56, 4
  s_cbranch_scc0 L_E2
  v_lshl_add_u32 v20, v38, 3, s5
  v_and_b32 v21, 14, v0
  v_lshlrev_b32 v21, 4, v21
  v_and_or_b32 v21, v0, 1, v21
  s_and_b32 s57, s2, 0x1e
  v_or_b32 v21, s57, v21
  v_cndmask_b32 v20, v20, v21, s[38:39]
  v_lshlrev_b32 v20, 4, v20
  s_mov_b32 s57, 7233792
  buffer_load_dwordx4 v[252:255], v20, s[28:31], s57 offen sc1
  s_branch L_NEXT
L_E2:
  s_mov_b32 s60, 200000
  s_branch L_PW_chk
L_PW_ld:
  buffer_load_dwordx4 v[252:255], v20, s[28:31], s57 offen sc1
L_PW_chk:
  s_waitcnt vmcnt(0)
  v_cmp_ne_u32 vcc, s34, v252
  v_cmp_ne_u32 s[58:59], s34, v253
  s_or_b64 vcc, vcc, s[58:59]
  v_cmp_ne_u32 s[58:59], s34, v254
  s_or_b64 vcc, vcc, s[58:59]
  v_cmp_ne_u32 s[58:59], s34, v255
  s_or_b64 vcc, vcc, s[58:59]
  s_sub_u32 s60, s60, 1
  s_cbranch_scc1 L_PW_ok
  s_cmp_eq_u64 vcc, 0
  s_cbranch_scc1 L_PW_ok
  s_sleep 8
  s_branch L_PW_ld
L_PW_ok:
  s_mul_i32 s56, s5, 204800
  s_mul_i32 s57, s6, 5120
  s_add_u32 s56, s56, s57
  s_add_u32 s56, s56, 5586944
  v_lshlrev_b32 v20, 4, v0
  v_add_u32 v21, 4096, v20
  buffer_load_dwordx4 v[152:155], v20, s[28:31], s56 offen offset:0 sc1
  buffer_load_dwordx4 v[172:175], v20, s[28:31], s56 offen offset:1024 sc1
  buffer_load_dwordx4 v[192:195], v20, s[28:31], s56 offen offset:2048 sc1
  buffer_load_dwordx4 v[212:215], v20, s[28:31], s56 offen offset:3072 sc1
  buffer_load_dwordx4 v[232:235], v21, s[28:31], s56 offen offset:0 sc1
  s_add_u32 s56, s56, 40960
  buffer_load_dwordx4 v[156:159], v20, s[28:31], s56 offen offset:0 sc1
  buffer_load_dwordx4 v[176:179], v20, s[28:31], s56 offen offset:1024 sc1
  buffer_load_dwordx4 v[196:199], v20, s[28:31], s56 offen offset:2048 sc1
  buffer_load_dwordx4 v[216:219], v20, s[28:31], s56 offen offset:3072 sc1
  buffer_load_dwordx4 v[236:239], v21, s[28:31], s56 offen offset:0 sc1
  s_add_u32 s56, s56, 40960
  buffer_load_dwordx4 v[160:163], v20, s[28:31], s56 offen offset:0 sc1
  buffer_load_dwordx4 v[180:183], v20, s[28:31], s56 offen offset:1024 sc1
  buffer_load_dwordx4 v[200:203], v20, s[28:31], s56 offen offset:2048 sc1
  buffer_load_dwordx4 v[220:223], v20, s[28:31], s56 offen offset:3072 sc1
  buffer_load_dwordx4 v[240:243], v21, s[28:31], s56 offen offset:0 sc1
  s_add_u32 s56, s56, 40960
  buffer_load_dwordx4 v[164:167], v20, s[28:31], s56 offen offset:0 sc1
  buffer_load_dwordx4 v[184:187], v20, s[28:31], s56 offen offset:1024 sc1
  buffer_load_dwordx4 v[204:207], v20, s[28:31], s56 offen offset:2048 sc1
  buffer_load_dwordx4 v[224:227], v20, s[28:31], s56 offen offset:3072 sc1
  buffer_load_dwordx4 v[244:247], v21, s[28:31], s56 offen offset:0 sc1
  s_add_u32 s56, s56, 40960
  buffer_load_dwordx4 v[168:171], v20, s[28:31], s56 offen offset:0 sc1
  buffer_load_dwordx4 v[188:191], v20, s[28:31], s56 offen offset:1024 sc1
  buffer_load_dwordx4 v[208:211], v20, s[28:31], s56 offen offset:2048 sc1
  buffer_load_dwordx4 v[228:231], v20, s[28:31], s56 offen offset:3072 sc1
  buffer_load_dwordx4 v[248:251], v21, s[28:31], s56 offen offset:0 sc1
  s_branch L_NEXT
L_REB0:
  s_cmp_eq_u32 s60, 0
  s_cbranch_scc1 L_GOB0
  s_sub_u32 s60, s60, 1
  s_waitcnt vmcnt(0) lgkmcnt(0)
  s_sleep 4
  buffer_load_dwordx4 v[16:19], v5, s[28:31], s17 offen offset:0 sc1
  buffer_load_dwordx4 v[20:23], v5, s[28:31], s17 offen offset:1024 sc1
  buffer_load_dwordx4 v[24:27], v5, s[28:31], s17 offen offset:2048 sc1
  buffer_load_dwordx4 v[28:31], v5, s[28:31], s17 offen offset:3072 sc1
  buffer_load_dwordx4 v[32:35], v6, s[28:31], s17 offen offset:0 sc1
  s_branch L_CHB0
L_REB1:
  s_cmp_eq_u32 s60, 0
  s_cbranch_scc1 L_GOB1
  s_sub_u32 s60, s60, 1
  s_waitcnt vmcnt(0) lgkmcnt(0)
  s_sleep 4
  buffer_load_dwordx4 v[36:39], v5, s[28:31], s18 offen offset:0 sc1
  buffer_load_dwordx4 v[40:43], v5, s[28:31], s18 offen offset:1024 sc1
  buffer_load_dwordx4 v[44:47], v5, s[28:31], s18 offen offset:2048 sc1
  buffer_load_dwordx4 v[48:51], v5, s[28:31], s18 offen offset:3072 sc1
  buffer_load_dwordx4 v[52:55], v6, s[28:31], s18 offen offset:0 sc1
  s_branch L_CHB1
L_REB2:
  s_cmp_eq_u32 s60, 0
  s_cbranch_scc1 L_GOB2
  s_sub_u32 s60, s60, 1
  s_waitcnt vmcnt(0) lgkmcnt(0)
  s_sleep 4
  buffer_load_dwordx4 v[56:59], v5, s[28:31], s19 offen offset:0 sc1
  buffer_load_dwordx4 v[60:63], v5, s[28:31], s19 offen offset:1024 sc1
  buffer_load_dwordx4 v[64:67], v5, s[28:31], s19 offen offset:2048 sc1
  buffer_load_dwordx4 v[68:71], v5, s[28:31], s19 offen offset:3072 sc1
  buffer_load_dwordx4 v[72:75], v6, s[28:31], s19 offen offset:0 sc1
  s_branch L_CHB2
L_REB3:
  s_cmp_eq_u32 s60, 0
  s_cbranch_scc1 L_GOB3
  s_sub_u32 s60, s60, 1
  s_waitcnt vmcnt(0) lgkmcnt(0)
  s_sleep 4
  buffer_load_dwordx4 v[76:79], v5, s[28:31], s20 offen offset:0 sc1
  buffer_load_dwordx4 v[80:83], v5, s[28:31], s20 offen offset:1024 sc1
  buffer_load_dwordx4 v[84:87], v5, s[28:31], s20 offen offset:2048 sc1
  buffer_load_dwordx4 v[88:91], v5, s[28:31], s20 offen offset:3072 sc1
  buffer_load_dwordx4 v[92:95], v6, s[28:31], s20 offen offset:0 sc1
  s_branch L_CHB3
L_REA0:
  s_cmp_eq_u32 s60, 0
  s_cbranch_scc1 L_GOA0
  s_sub_u32 s60, s60, 1
  s_waitcnt vmcnt(0) lgkmcnt(0)
  s_sleep 4
  buffer_load_dwordx4 v[16:19], v5, s[28:31], s17 offen offset:0 sc1
  buffer_load_dwordx4 v[20:23], v5, s[28:31], s17 offen offset:1024 sc1
  buffer_load_dwordx4 v[24:27], v5, s[28:31], s17 offen offset:2048 sc1
  buffer_load_dwordx4 v[28:31], v5, s[28:31], s17 offen offset:3072 sc1
  buffer_load_dwordx4 v[32:35], v6, s[28:31], s17 offen offset:0 sc1
  buffer_load_dwordx4 v[36:39], v5, s[28:31], s18 offen offset:0 sc1
  buffer_load_dwordx4 v[40:43], v5, s[28:31], s18 offen offset:1024 sc1
  buffer_load_dwordx4 v[44:47], v5, s[28:31], s18 offen offset:2048 sc1
  buffer_load_dwordx4 v[48:51], v5, s[28:31], s18 offen offset:3072 sc1
  buffer_load_dwordx4 v[52:55], v6, s[28:31], s18 offen offset:0 sc1
  buffer_load_dwordx4 v[56:59], v5, s[28:31], s19 offen offset:0 sc1
  buffer_load_dwordx4 v[60:63], v5, s[28:31], s19 offen offset:1024 sc1
  buffer_load_dwordx4 v[64:67], v5, s[28:31], s19 offen offset:2048 sc1
  buffer_load_dwordx4 v[68:71], v5, s[28:31], s19 offen offset:3072 sc1
  buffer_load_dwordx4 v[72:75], v6, s[28:31], s19 offen offset:0 sc1
  buffer_load_dwordx4 v[76:79], v5, s[28:31], s20 offen offset:0 sc1
  buffer_load_dwordx4 v[80:83], v5, s[28:31], s20 offen offset:1024 sc1
  buffer_load_dwordx4 v[84:87], v5, s[28:31], s20 offen offset:2048 sc1
  buffer_load_dwordx4 v[88:91], v5, s[28:31], s20 offen offset:3072 sc1
  buffer_load_dwordx4 v[92:95], v6, s[28:31], s20 offen offset:0 sc1
  s_branch L_CHA0
L_REA1:
  s_cmp_eq_u32 s60, 0
  s_cbranch_scc1 L_GOA1
  s_sub_u32 s60, s60, 1
  s_waitcnt vmcnt(0) lgkmcnt(0)
  s_sleep 4
  buffer_load_dwordx4 v[36:39], v5, s[28:31], s18 offen offset:0 sc1
  buffer_load_dwordx4 v[40:43], v5, s[28:31], s18 offen offset:1024 sc1
  buffer_load_dwordx4 v[44:47], v5, s[28:31], s18 offen offset:2048 sc1
  buffer_load_dwordx4 v[48:51], v5, s[28:31], s18 offen offset:3072 sc1
  buffer_load_dwordx4 v[52:55], v6, s[28:31], s18 offen offset:0 sc1
  buffer_load_dwordx4 v[56:59], v5, s[28:31], s19 offen offset:0 sc1
  buffer_load_dwordx4 v[60:63], v5, s[28:31], s19 offen offset:1024 sc1
  buffer_load_dwordx4 v[64:67], v5, s[28:31], s19 offen offset:2048 sc1
  buffer_load_dwordx4 v[68:71], v5, s[28:31], s19 offen offset:3072 sc1
  buffer_load_dwordx4 v[72:75], v6, s[28:31], s19 offen offset:0 sc1
  buffer_load_dwordx4 v[76:79], v5, s[28:31], s20 offen offset:0 sc1
  buffer_load_dwordx4 v[80:83], v5, s[28:31], s20 offen offset:1024 sc1
  buffer_load_dwordx4 v[84:87], v5, s[28:31], s20 offen offset:2048 sc1
  buffer_load_dwordx4 v[88:91], v5, s[28:31], s20 offen offset:3072 sc1
  buffer_load_dwordx4 v[92:95], v6, s[28:31], s20 offen offset:0 sc1
  s_branch L_CHA1
L_REA2:
  s_cmp_eq_u32 s60, 0
  s_cbranch_scc1 L_GOA2
  s_sub_u32 s60, s60, 1
  s_waitcnt vmcnt(0) lgkmcnt(0)
  s_sleep 4
  buffer_load_dwordx4 v[56:59], v5, s[28:31], s19 offen offset:0 sc1
  buffer_load_dwordx4 v[60:63], v5, s[28:31], s19 offen offset:1024 sc1
  buffer_load_dwordx4 v[64:67], v5, s[28:31], s19 offen offset:2048 sc1
  buffer_load_dwordx4 v[68:71], v5, s[28:31], s19 offen offset:3072 sc1
  buffer_load_dwordx4 v[72:75], v6, s[28:31], s19 offen offset:0 sc1
  buffer_load_dwordx4 v[76:79], v5, s[28:31], s20 offen offset:0 sc1
  buffer_load_dwordx4 v[80:83], v5, s[28:31], s20 offen offset:1024 sc1
  buffer_load_dwordx4 v[84:87], v5, s[28:31], s20 offen offset:2048 sc1
  buffer_load_dwordx4 v[88:91], v5, s[28:31], s20 offen offset:3072 sc1
  buffer_load_dwordx4 v[92:95], v6, s[28:31], s20 offen offset:0 sc1
  s_branch L_CHA2
L_REA3:
  s_cmp_eq_u32 s60, 0
  s_cbranch_scc1 L_GOA3
  s_sub_u32 s60, s60, 1
  s_waitcnt vmcnt(0) lgkmcnt(0)
  s_sleep 4
  buffer_load_dwordx4 v[76:79], v5, s[28:31], s20 offen offset:0 sc1
  buffer_load_dwordx4 v[80:83], v5, s[28:31], s20 offen offset:1024 sc1
  buffer_load_dwordx4 v[84:87], v5, s[28:31], s20 offen offset:2048 sc1
  buffer_load_dwordx4 v[88:91], v5, s[28:31], s20 offen offset:3072 sc1
  buffer_load_dwordx4 v[92:95], v6, s[28:31], s20 offen offset:0 sc1
  s_branch L_CHA3
L_BAD:
  s_cmp_eq_u32 s42, 0
  s_cbranch_scc1 L_OK
  s_mov_b32 s42, 0
  s_mov_b32 s45, 0
  s_mov_b32 s40, 0xffff0000
  s_mov_b32 s43, 64
  v_subrev_u32 v3, 163840, v3
  v_subrev_u32 v2, 163840, v2
  v_subrev_u32 v1, 163840, v1
  v_mov_b32 v20, v3
  v_mov_b32 v21, v2
  v_mov_b32 v9, 0
  v_mov_b32 v22, 0xff800000
  v_mov_b32 v17, 0
  v_mov_b32 v23, 0xff800000
  v_mov_b32 v56, 0
  v_mov_b32 v57, 0
  v_mov_b32 v58, 0
  v_mov_b32 v59, 0
  v_mov_b32 v60, 0
  v_mov_b32 v61, 0
  v_mov_b32 v62, 0
  v_mov_b32 v63, 0
  v_mov_b32 v64, 0
  v_mov_b32 v65, 0
  v_mov_b32 v66, 0
  v_mov_b32 v67, 0
  v_mov_b32 v68, 0
  v_mov_b32 v69, 0
  v_mov_b32 v70, 0
  v_mov_b32 v71, 0
  v_mov_b32 v72, 0
  v_mov_b32 v73, 0
  v_mov_b32 v74, 0
  v_mov_b32 v75, 0
  v_mov_b32 v76, 0
  v_mov_b32 v77, 0
  v_mov_b32 v78, 0
  v_mov_b32 v79, 0
  v_mov_b32 v80, 0
  v_mov_b32 v81, 0
  v_mov_b32 v82, 0
  v_mov_b32 v83, 0
  v_mov_b32 v84, 0
  v_mov_b32 v85, 0
  v_mov_b32 v86, 0
  v_mov_b32 v87, 0
  v_mov_b32 v136, 0
  v_mov_b32 v137, 0
  v_mov_b32 v138, 0
  v_mov_b32 v139, 0
  v_mov_b32 v140, 0
  v_mov_b32 v141, 0
  v_mov_b32 v142, 0
  v_mov_b32 v143, 0
  v_mov_b32 v144, 0
  v_mov_b32 v145, 0
  v_mov_b32 v146, 0
  v_mov_b32 v147, 0
  v_mov_b32 v148, 0
  v_mov_b32 v149, 0
  v_mov_b32 v150, 0
  v_mov_b32 v151, 0
L_MAXL:
  ds_read_b128 v[24:27], v20
  ds_read_b32 v28, v21 offset:1024
  v_add_u32 v20, 2560, v20
  v_add_u32 v21, 2560, v21
  s_waitcnt lgkmcnt(0)
  v_mfma_f32_32x32x16_bf16 v[88:103], v[24:27], v[4:7], 0
  v_mfma_f32_32x32x8_bf16 v[88:103], v[28:29], v[8:9], v[88:103]
  v_mfma_f32_32x32x16_bf16 v[104:119], v[24:27], v[12:15], 0
  v_mfma_f32_32x32x8_bf16 v[104:119], v[28:29], v[16:17], v[104:119]
  s_nop 11
  v_max3_f32 v22, v88, v89, v22
  v_max3_f32 v22, v90, v91, v22
  v_max3_f32 v22, v92, v93, v22
  v_max3_f32 v22, v94, v95, v22
  v_max3_f32 v22, v96, v97, v22
  v_max3_f32 v22, v98, v99, v22
  v_max3_f32 v22, v100, v101, v22
  v_max3_f32 v22, v102, v103, v22
  v_max3_f32 v23, v104, v105, v23
  v_max3_f32 v23, v106, v107, v23
  v_max3_f32 v23, v108, v109, v23
  v_max3_f32 v23, v110, v111, v23
  v_max3_f32 v23, v112, v113, v23
  v_max3_f32 v23, v114, v115, v23
  v_max3_f32 v23, v116, v117, v23
  v_max3_f32 v23, v118, v119, v23
  s_sub_u32 s43, s43, 1
  s_cmp_lg_u32 s43, 0
  s_cbranch_scc1 L_MAXL
  ds_read_b128 v[24:27], v3 offset:0
  ds_read_b32 v28, v2 offset:1024
  ds_read_b128 v[32:35], v3 offset:2560
  ds_read_b32 v36, v2 offset:3584
  s_mov_b64 exec, s[36:37]
  ds_read_b128 v[48:51], v1 offset:1280
  ds_read_b128 v[52:55], v1 offset:1920
  s_mov_b64 exec, -1
  v_mov_b32 v20, v22
  s_nop 1
  v_permlane32_swap_b32 v22, v20
  s_nop 1
  v_min_f32 v22, -v22, -v20
  v_and_b32 v20, s40, v22
  v_sub_f32 v21, v22, v20
  v_lshrrev_b32 v20, 16, v20
  v_and_or_b32 v20, v21, s40, v20
  v_and_b32 v22, s40, v21
  v_sub_f32 v21, v21, v22
  v_and_b32 v21, s40, v21
  v_cndmask_b32 v9, v20, v21, s[38:39]
  v_mov_b32 v20, v23
  s_nop 1
  v_permlane32_swap_b32 v23, v20
  s_nop 1
  v_min_f32 v23, -v23, -v20
  v_and_b32 v20, s40, v23
  v_sub_f32 v21, v23, v20
  v_lshrrev_b32 v20, 16, v20
  v_and_or_b32 v20, v21, s40, v20
  v_and_b32 v23, s40, v21
  v_sub_f32 v21, v21, v23
  v_and_b32 v21, s40, v21
  v_cndmask_b32 v17, v20, v21, s[38:39]
  s_waitcnt lgkmcnt(0)
  s_nop 0
  v_mfma_f32_32x32x16_bf16 v[88:103], v[24:27], v[4:7], 0
  v_mfma_f32_32x32x8_bf16 v[88:103], v[28:29], v[8:9], v[88:103]
  s_mov_b32 s44, 8
  s_setprio 1
  s_nop 9
  s_branch L_LOOP
L_END:
  s_endpgm
.section .rodata,"a"
.p2align 6
.amdhsa_kernel gated_mix__grouped_kv_mqa__grouped_kv_mqa__prompt_kernel
  .amdhsa_next_free_vgpr 256
  .amdhsa_next_free_sgpr 102
  .amdhsa_accum_offset 256
  .amdhsa_group_segment_fixed_size 0
  .amdhsa_kernarg_size 112
  .amdhsa_user_sgpr_count 2
  .amdhsa_user_sgpr_kernarg_segment_ptr 1
  .amdhsa_system_sgpr_workgroup_id_x 1
.end_amdhsa_kernel
```
